```python
import torch

def _softmax(x, axis=-1):
    return torch.softmax(x, dim=axis)
def _gelu(x):
    return torch.nn.functional.gelu(x, approximate="tanh")
def _silu(x):
    return torch.nn.functional.silu(x)
def _sigmoid(x):
    return torch.sigmoid(x)
def _layernorm(x, axis=-1, eps=1e-5):
    m = x.mean(dim=axis, keepdim=True)
    v = x.var(dim=axis, keepdim=True, unbiased=False)
    return (x - m) / torch.sqrt(v + eps)
def _scatter_add(tgt, idx, src, axis=0):
    return tgt.clone().index_add_(axis, idx, src)
def _segment_sum(src, seg, n):
    out = torch.zeros((n,) + src.shape[1:], dtype=src.dtype)
    return out.index_add_(0, seg, src)
def _pad(x, pw):
    flat = tuple(v for pair in reversed(pw) for v in pair)
    return torch.nn.functional.pad(x, flat)

kernel_name = 'concat_heads__ssm_conv_s5__ssm_conv_s5__prompt'

def setup_inputs():

    _w = (lambda a: (lambda t: t.to(torch.bfloat16) if t.is_floating_point() else t)(torch.as_tensor(a)))
    def _A_setup():
        B, S, D = 1, 2048, 576
        P = D
        Lambda_re = -0.5 * (lambda _x: torch.exp(torch.as_tensor(_x)))((lambda *s: torch.randn(*s, dtype=torch.bfloat16) * 0.2)(P))
        Lambda_im = (lambda *s: torch.randn(*s, dtype=torch.bfloat16) * 0.4)(P) * 1.0
        B_re = (lambda *s: torch.randn(*s, dtype=torch.bfloat16) * 0.2)(P, D) * (D ** -0.5)
        B_im = (lambda *s: torch.randn(*s, dtype=torch.bfloat16) * 0.2)(P, D) * (D ** -0.5)
        C_re = (lambda *s: torch.randn(*s, dtype=torch.bfloat16) * 0.2)(D, P) * (P ** -0.5)
        C_im = (lambda *s: torch.randn(*s, dtype=torch.bfloat16) * 0.2)(D, P) * (P ** -0.5)
        log_dt = (lambda *s: torch.randn(*s, dtype=torch.bfloat16) * 0.2)(P) * 0.3 - 2.0
        Dskip = (lambda *s: torch.randn(*s, dtype=torch.bfloat16) * 0.05)(D)
        return {
            "x": _w((lambda *s: torch.randn(*s, dtype=torch.bfloat16) * 0.05)(B, S, D)),
            "Lambda_re": _w(Lambda_re),
            "Lambda_im": _w(Lambda_im),
            "B_re": _w(B_re),
            "B_im": _w(B_im),
            "C_re": _w(C_re),
            "C_im": _w(C_im),
            "log_dt": _w(log_dt),
            "Dskip": _w(Dskip),
        }
    _A_in = _A_setup()

    def _B_setup():
        B, S, D = 1, 2048, 576
        P = D
        Lambda_re = -0.5 * (lambda _x: torch.exp(torch.as_tensor(_x)))((lambda *s: torch.randn(*s, dtype=torch.bfloat16) * 0.2)(P))
        Lambda_im = (lambda *s: torch.randn(*s, dtype=torch.bfloat16) * 0.4)(P) * 1.0
        B_re = (lambda *s: torch.randn(*s, dtype=torch.bfloat16) * 0.2)(P, D) * (D ** -0.5)
        B_im = (lambda *s: torch.randn(*s, dtype=torch.bfloat16) * 0.2)(P, D) * (D ** -0.5)
        C_re = (lambda *s: torch.randn(*s, dtype=torch.bfloat16) * 0.2)(D, P) * (P ** -0.5)
        C_im = (lambda *s: torch.randn(*s, dtype=torch.bfloat16) * 0.2)(D, P) * (P ** -0.5)
        log_dt = (lambda *s: torch.randn(*s, dtype=torch.bfloat16) * 0.2)(P) * 0.3 - 2.0
        Dskip = (lambda *s: torch.randn(*s, dtype=torch.bfloat16) * 0.05)(D)
        return {
            "x": _w((lambda *s: torch.randn(*s, dtype=torch.bfloat16) * 0.05)(B, S, D)),
            "Lambda_re": _w(Lambda_re),
            "Lambda_im": _w(Lambda_im),
            "B_re": _w(B_re),
            "B_im": _w(B_im),
            "C_re": _w(C_re),
            "C_im": _w(C_im),
            "log_dt": _w(log_dt),
            "Dskip": _w(Dskip),
        }
    _B_in = _B_setup()

    return {
        "A_x": _A_in["x"],
        "A_Lambda_re": _A_in["Lambda_re"],
        "A_Lambda_im": _A_in["Lambda_im"],
        "A_B_re": _A_in["B_re"],
        "A_B_im": _A_in["B_im"],
        "A_C_re": _A_in["C_re"],
        "A_C_im": _A_in["C_im"],
        "A_log_dt": _A_in["log_dt"],
        "A_Dskip": _A_in["Dskip"],
        "B_x": _B_in["x"],
        "B_Lambda_re": _B_in["Lambda_re"],
        "B_Lambda_im": _B_in["Lambda_im"],
        "B_B_re": _B_in["B_re"],
        "B_B_im": _B_in["B_im"],
        "B_C_re": _B_in["C_re"],
        "B_C_im": _B_in["C_im"],
        "B_log_dt": _B_in["log_dt"],
        "B_Dskip": _B_in["Dskip"],
    }

def reference(A_x, A_Lambda_re, A_Lambda_im, A_B_re, A_B_im, A_C_re, A_C_im, A_log_dt, A_Dskip, B_x, B_Lambda_re, B_Lambda_im, B_B_re, B_B_im, B_C_re, B_C_im, B_log_dt, B_Dskip):
    def _A_ref(x, Lambda_re, Lambda_im, B_re, B_im, C_re, C_im, log_dt, Dskip):
        Bsz, L, H = x.shape
        Lam = Lambda_re + 1j * Lambda_im
        Bmat = B_re + 1j * B_im
        Cmat = C_re + 1j * C_im
        dt = torch.exp(log_dt)
        Lam_bar = torch.exp(dt * Lam)
        B_bar = ((Lam_bar - 1.0) / Lam)[:, None] * Bmat
        Bu = torch.einsum("bld,pd->blp", x + 0j, B_bar)
        h = torch.zeros_like(Bu[:, 0, :])
        hs = []
        for t in range(L):
            h = Lam_bar[None, :] * h + Bu[:, t, :]
            hs.append(h)
        hseq = torch.stack(hs, 1)
        y = 2.0 * torch.einsum("blp,dp->bld", hseq, Cmat).real + x * Dskip[None, None, :]
        return y

    def _B_ref(x, Lambda_re, Lambda_im, B_re, B_im, C_re, C_im, log_dt, Dskip):
        Bsz, L, H = x.shape
        Lam = Lambda_re + 1j * Lambda_im
        Bmat = B_re + 1j * B_im
        Cmat = C_re + 1j * C_im
        dt = torch.exp(log_dt)
        Lam_bar = torch.exp(dt * Lam)
        B_bar = ((Lam_bar - 1.0) / Lam)[:, None] * Bmat
        Bu = torch.einsum("bld,pd->blp", x + 0j, B_bar)
        h = torch.zeros_like(Bu[:, 0, :])
        hs = []
        for t in range(L):
            h = Lam_bar[None, :] * h + Bu[:, t, :]
            hs.append(h)
        hseq = torch.stack(hs, 1)
        y = 2.0 * torch.einsum("blp,dp->bld", hseq, Cmat).real + x * Dskip[None, None, :]
        return y

    a = _A_ref(A_x, A_Lambda_re, A_Lambda_im, A_B_re, A_B_im, A_C_re, A_C_im, A_log_dt, A_Dskip)
    b = _B_ref(B_x, B_Lambda_re, B_Lambda_im, B_B_re, B_B_im, B_C_re, B_C_im, B_log_dt, B_Dskip)
    return torch.concatenate([a, b], axis=-1)
```

```asm
; @launch grid=(256,1,1) block=(256,1,1) lds=163840
.amdgcn_target "amdgcn-amd-amdhsa--gfx950"
.text
.globl concat_heads__ssm_conv_s5__ssm_conv_s5__prompt_kernel
.p2align 8
.type concat_heads__ssm_conv_s5__ssm_conv_s5__prompt_kernel,@function
.set CODE_LAST, 21448
concat_heads__ssm_conv_s5__ssm_conv_s5__prompt_kernel:
    s_cmp_ge_u32 s2, 256
    s_cbranch_scc1 L_end
    s_getpc_b64 s[64:65]
L_pc:
    v_lshrrev_b32 v228, 6, v0
    s_and_b32 s48, s2, 1
    v_lshrrev_b32 v229, 2, v0
    s_lshl_b32 s3, s2, 3
    s_and_b32 s3, s3, 0xc0
    v_add_lshl_u32 v229, v229, s3, 7
    v_readfirstlane_b32 s51, v228
    s_mul_i32 s56, s48, 72
    v_min_u32 v229, CODE_LAST, v229
    s_load_dwordx2 s[4:5], s[0:1], s56
    s_load_dwordx2 s[8:9], s[0:1], s56 offset:24
    s_load_dwordx2 s[12:13], s[0:1], s56 offset:32
    s_load_dwordx4 s[80:83], s[0:1], s56 offset:8
    s_load_dwordx4 s[84:87], s[0:1], s56 offset:56
    s_lshr_b32 s57, s51, 1
    s_lshl_b32 s57, s57, 3
    s_add_u32 s57, s57, s56
    s_load_dwordx2 s[16:17], s[0:1], s57 offset:24
    global_load_dword v251, v229, s[64:65]
    v_and_b32 v1, 63, v0
    v_lshrrev_b32 v230, 3, v1
    v_and_b32 v231, 7, v1
    v_lshrrev_b32 v234, 1, v230
    s_and_b32 s3, s2, 6
    s_lshr_b32 s55, s2, 3
    s_lshr_b32 s3, s3, 1
    s_lshr_b32 s70, s55, 3
    s_lshl2_add_u32 s49, s3, s70
    s_and_b32 s50, s55, 7
    s_add_u32 s70, s70, s50
    v_xor_b32 v232, v231, v234
    v_lshlrev_b32 v232, 4, v232
    v_lshrrev_b32 v233, 2, v230
    v_lshlrev_b32 v233, 5, v233
    v_and_b32 v235, 1, v230
    v_lshl_add_u32 v233, v235, 4, v233
    v_and_b32 v235, 1, v234
    v_add_u32 v233, v233, v235
    v_mul_u32_u24 v233, 1152, v233
    v_mul_u32_u24 v236, 1152, v230
    s_lshl_b32 s55, s49, 7
    s_lshl_b32 s3, s51, 2
    s_add_u32 s55, s55, s3
    s_mul_i32 s55, s55, 1152
    v_add3_u32 v4, v233, v232, s55
    v_xor_b32 v237, 64, v232
    s_add_u32 s55, s55, 72704
    v_add3_u32 v5, v233, v237, s55
    v_add_u32 v6, 256, v4
    v_add_u32 v7, 256, v5
    s_lshl_b32 s55, s50, 6
    s_lshl_b32 s3, s51, 4
    s_add_u32 s3, s55, s3
    s_lshl_b32 s55, s50, 3
    s_mul_i32 s54, s3, 1152
    v_add3_u32 v8, v236, v232, s54
    s_add_u32 s54, s54, 8192
    v_add3_u32 v9, v236, v237, s54
    v_and_b32 v3, 15, v0
    v_add_lshl_u32 v238, v3, s3, 1
    v_and_b32 v239, 7, v0
    v_add_lshl_u32 v239, v239, s55, 1
    s_and_b32 s3, s51, 1
    s_lshl_b32 s3, s3, 2
    s_add_u32 s55, s55, s3
    s_add_u32 s55, s55, 512
    s_mul_i32 s55, s55, 1152
    s_lshl_b32 s3, s51, 1
    v_add_u32 v240, s3, v234
    v_xor_b32 v240, v231, v240
    v_lshlrev_b32 v240, 4, v240
    v_add3_u32 v10, v236, v240, s55
    s_lshl_b32 s58, s51, 12
    s_add_u32 s59, s58, 49152
    s_lshl_b32 s60, s51, 9
    s_add_u32 s60, s60, 98304
    s_mov_b32 s6, 2359296
    s_mov_b32 s7, 0x20000
    s_mov_b32 s10, 663552
    s_mov_b32 s11, 0x20000
    s_mov_b32 s14, 663552
    s_mov_b32 s15, 0x20000
    s_mov_b32 s18, 663552
    s_mov_b32 s19, 0x20000
    s_mov_b32 s54, s70
    s_mul_i32 s3, s54, 0x5556
    s_lshr_b32 s3, s3, 16
    s_mul_i32 s3, s3, 3
    s_sub_u32 s54, s54, s3
    s_mul_i32 s96, s54, 384
    s_add_u32 s97, s96, 384
    s_cmp_eq_u32 s97, 1152
    s_cselect_b32 s97, 0, s97
    s_add_u32 s98, s97, 384
    s_cmp_eq_u32 s98, 1152
    s_cselect_b32 s98, 0, s98
    s_waitcnt lgkmcnt(0)
    global_load_ushort v140, v238, s[80:81]
    global_load_ushort v141, v238, s[82:83]
    global_load_ushort v142, v238, s[84:85]
    global_load_ushort v143, v239, s[80:81] offset:1024
    global_load_ushort v144, v239, s[82:83] offset:1024
    global_load_ushort v145, v239, s[84:85] offset:1024
    s_add_u32 m0, s58, 0
    s_add_u32 s54, s96, 0
    buffer_load_dwordx4 v4, s[4:7], s54 offen lds
    buffer_load_dwordx4 v5, s[4:7], s54 offen offset:1024 lds
    buffer_load_dwordx4 v6, s[4:7], s54 offen offset:2048 lds
    buffer_load_dwordx4 v7, s[4:7], s54 offen offset:3072 lds
    s_add_u32 m0, s59, 0
    s_nop 0
    buffer_load_dwordx4 v8, s[8:11], s54 offen lds
    buffer_load_dwordx4 v9, s[8:11], s54 offen offset:1024 lds
    s_add_u32 m0, s59, 2048
    s_nop 0
    buffer_load_dwordx4 v8, s[12:15], s54 offen lds
    buffer_load_dwordx4 v9, s[12:15], s54 offen offset:1024 lds
    s_add_u32 m0, s60, 0
    s_mov_b32 exec_hi, 0
    buffer_load_dwordx4 v10, s[16:19], s54 offen lds
    s_mov_b32 exec_hi, -1
    s_load_dwordx2 s[20:21], s[0:1], s56 offset:40
    s_load_dwordx2 s[24:25], s[0:1], s56 offset:48
    s_load_dwordx2 s[44:45], s[0:1], s57 offset:40
    s_load_dwordx2 s[32:33], s[0:1], 144
    s_load_dwordx2 s[36:37], s[0:1], 152
    s_load_dwordx2 s[28:29], s[0:1], 160
    s_mov_b32 s22, 663552
    s_mov_b32 s23, 0x20000
    s_mov_b32 s26, 663552
    s_mov_b32 s27, 0x20000
    s_mov_b32 s46, 663552
    s_mov_b32 s47, 0x20000
    s_mov_b32 s34, 9437184
    s_mov_b32 s35, 0x20000
    s_mov_b32 s38, 256
    s_mov_b32 s39, 0x20000
    s_mov_b32 s30, 10485760
    s_mov_b32 s31, 0x20000
    s_mov_b32 s42, 12288
    s_mov_b32 s43, 0x20000
    v_lshrrev_b32 v2, 4, v1
    s_lshr_b32 s52, s50, 2
    s_and_b32 s53, s50, 3
    v_lshrrev_b32 v244, 1, v3
    v_xor_b32 v244, v2, v244
    v_lshlrev_b32 v244, 4, v244
    v_lshl_add_u32 v13, v3, 7, v244
    v_xor_b32 v14, 64, v13
    v_add_u32 v19, s58, v13
    v_add_u32 v20, s58, v14
    v_add_u32 v15, s59, v13
    v_add_u32 v16, s59, v14
    v_add_u32 v17, 98304, v13
    v_add_u32 v18, 98304, v14
    s_lshl_b32 s55, s48, 3
    s_add_u32 s55, s55, s50
    s_mul_i32 s76, s55, 12288
    s_mul_i32 s56, s49, 768
    s_add_u32 s55, s76, s56
    s_lshl_b32 s57, s51, 7
    v_lshlrev_b32 v241, 3, v3
    v_add_u32 v241, s57, v241
    v_and_b32 v242, 7, v3
    v_lshlrev_b32 v242, 4, v242
    v_lshrrev_b32 v243, 3, v3
    v_lshl_add_u32 v244, v2, 2, v241
    v_add_u32 v21, s55, v244
    s_mul_i32 s57, s51, 0x48
    s_and_b32 s57, s57, 0x88
    s_add_u32 s57, s57, s55
    s_add_u32 s57, s57, 512
    v_lshl_add_u32 v244, v243, 2, v242
    v_add_u32 v244, s57, v244
    v_cmp_eq_u32 vcc, 2, v2
    s_lshl_b32 s55, s48, 4
    s_add_u32 s55, s55, s49
    v_cndmask_b32 v21, v21, v244, vcc
    s_mul_i32 s63, s55, 294912
    s_add_u32 s63, s63, 1048576
    s_lshl_b32 s3, s55, 10
    s_add_u32 s3, s3, 262144
    s_lshl_b32 s57, s50, 7
    s_add_u32 s55, s3, s57
    s_cmp_eq_u32 s51, 0
    s_cselect_b32 s55, s55, 0x7ffffff0
    v_mov_b32 v244, s55
    v_cmp_eq_u32 vcc, 48, v1
    v_mov_b32 v12, 1
    v_mov_b32 v245, -1
    v_cndmask_b32 v21, v21, v244, vcc
    v_cndmask_b32_e64 v245, v245, 0, vcc
    v_mov_b32 v244, 0x7ffffff0
    v_cmp_lt_u32 vcc, 48, v1
    v_and_b32 v127, 7, v1
    v_lshlrev_b32 v127, 7, v127
    v_cndmask_b32 v21, v21, v244, vcc
    v_add_u32 v127, s3, v127
    s_waitcnt lgkmcnt(0)
    s_add_u32 s28, s28, 0
    s_addc_u32 s29, s29, 0
    s_add_u32 s40, s28, s76
    s_addc_u32 s41, s29, 0
    v_mov_b32 v160, v245
    s_sub_u32 s56, s49, 1
    v_sub_u32 v244, s56, v2
    v_mul_i32_i24 v244, 768, v244
    v_add_u32 v22, v244, v241
    v_lshlrev_b32 v246, 4, v3
    v_add_u32 v246, 512, v246
    v_add_u32 v26, v244, v246
    v_subrev_u32 v23, 3072, v22
    v_subrev_u32 v27, 3072, v26
    v_subrev_u32 v24, 6144, v22
    v_subrev_u32 v28, 6144, v26
    v_subrev_u32 v25, 9216, v22
    v_subrev_u32 v29, 9216, v26
    s_mul_i32 s55, s53, 288
    s_lshl_b32 s56, s51, 6
    v_lshlrev_b32 v161, 1, v3
    v_add_u32 v161, s55, v161
    v_add_u32 v162, s56, v161
    s_mov_b64 s[100:101], s[86:87]
    v_lshlrev_b32 v246, 4, v1
    s_lshl_b32 s55, s50, 2
    s_add_u32 s55, s55, s51
    s_lshl_b32 s55, s55, 11
    s_add_u32 s55, s55, s63
    v_add_u32 v30, s55, v246
    s_lshr_b32 s56, s50, 1
    s_lshl_b32 s56, s56, 11
    s_and_b32 s55, s50, 1
    s_lshl_b32 s55, s55, 7
    s_add_u32 s55, s55, s56
    s_and_b32 s56, s51, 1
    s_lshl_b32 s57, s56, 10
    s_add_u32 s55, s55, s57
    s_lshr_b32 s57, s51, 1
    s_mul_i32 s76, s57, 147456
    s_add_u32 s55, s55, s76
    s_add_u32 s55, s55, s63
    s_add_u32 s55, s55, 65536
    v_mul_u32_u24 v245, 73600, v243
    v_add3_u32 v31, v246, v245, s55
    s_mul_i32 s55, s52, 147456
    s_add_u32 s63, s63, s55
    s_mul_i32 s55, s57, 73728
    s_add_u32 s63, s63, s55
    s_lshl_b32 s55, s56, 12
    s_add_u32 s63, s63, s55
    s_lshl_b32 s3, s50, 7
    s_lshr_b32 s55, s2, 6
    s_mul_i32 s55, s55, 0x01010101
    s_add_u32 s55, s55, 0x03020100
    s_and_b32 s55, s55, 0x03030303
    s_xor_b32 s56, s52, 1
    s_mul_i32 s56, s56, 0x04040404
    s_or_b32 s1, s55, s56
    s_mul_i32 s55, s53, 144
    s_lshl_b32 s56, s51, 5
    s_add_u32 s56, s55, s56
    s_mul_i32 s56, s56, 1152
    v_add3_u32 v252, v236, v232, s56
    s_add_u32 s56, s56, 8192
    v_add3_u32 v253, v236, v237, s56
    v_add_u32 v254, 16384, v252
    v_add_u32 v255, 16384, v253
    s_and_b32 s56, s51, 1
    s_lshl_b32 s57, s56, 3
    s_add_u32 s55, s55, s57
    s_add_u32 s55, s55, 128
    s_mul_i32 s55, s55, 1152
    s_lshl_b32 s57, s56, 6
    v_xor_b32 v244, s57, v232
    v_add3_u32 v11, v236, v244, s55
    s_lshr_b32 s57, s51, 1
    s_lshl_b32 s62, s57, 11
    s_lshl_b32 s55, s56, 10
    s_add_u32 s62, s62, s55
    s_add_u32 s62, s62, 126976
    v_lshlrev_b32 v244, 5, v2
    v_bfe_u32 v245, v1, 2, 1
    v_lshl_add_u32 v244, v245, 4, v244
    v_bfe_u32 v245, v1, 3, 1
    v_add_u32 v244, v244, v245
    v_and_b32 v245, 1, v2
    v_xor_b32 v245, s56, v245
    v_lshl_add_u32 v242, v245, 1, v244
    v_xor_b32 v245, 1, v245
    v_lshl_add_u32 v243, v245, 1, v244
    v_mul_u32_u24 v242, 1152, v242
    v_mul_u32_u24 v243, 1152, v243
    v_and_b32 v244, 3, v1
    v_lshlrev_b32 v244, 4, v244
    s_mul_i32 s55, s49, 147456
    s_mul_i32 s57, s53, 288
    s_add_u32 s55, s55, s57
    s_lshl_b32 s57, s51, 6
    s_add_u32 s57, s57, s55
    v_add3_u32 v246, v242, v244, s57
    v_add3_u32 v247, v243, v244, s57
    v_and_b32 v244, 16, v244
    s_add_u32 s55, s55, 256
    v_add3_u32 v248, v242, v244, s55
    s_lshr_b32 s55, s51, 1
    s_lshl_b32 s56, s52, 1
    s_add_u32 s57, s56, s55
    s_xor_b32 s55, s55, 1
    s_add_u32 s56, s56, s55
    s_mul_i32 s72, s57, 4608
    s_mul_i32 s73, s56, 4608
    s_mul_i32 s64, s57, 18432
    s_mul_i32 s68, s56, 18432
    s_add_u32 s65, s64, 73728
    s_add_u32 s66, s64, 4608
    s_add_u32 s67, s64, 78336
    s_add_u32 s69, s68, 73728
    s_add_u32 s70, s68, 4608
    s_add_u32 s71, s68, 78336
    s_mov_b32 s77, 73728
    s_mov_b32 s78, 147456
    s_mov_b32 s79, 221184
    s_lshl_b32 s61, s51, 10
    s_add_u32 s61, s61, 114688
    s_lshr_b32 s55, s2, 5
    s_lshl_b32 s55, s55, 1
    s_and_b32 s56, s51, 1
    s_add_u32 s55, s55, s56
    s_mul_i32 s55, s55, 9
    s_mul_i32 s56, s53, 144
    s_add_u32 s55, s55, s56
    s_mul_i32 s55, s55, 1152
    s_add_u32 s55, s55, 1024
    v_mul_u32_u24 v245, 1152, v1
    v_add_u32 v245, s55, v245
    s_lshl_b32 s55, s48, 7
    v_and_b32 v155, 31, v1
    v_lshlrev_b32 v155, 2, v155
    v_add_u32 v155, s55, v155
    s_lshr_b32 s56, s2, 3
    s_lshl_b32 s56, s56, 2
    s_add_u32 s55, s55, s56
    v_mov_b32 v249, s55
    v_mov_b32 v244, 0x7ffffff0
    v_cmp_eq_u32 vcc, s53, v0
    v_mov_b32 v250, 1
    s_nop 0
    v_cndmask_b32 v249, v244, v249, vcc
    s_waitcnt vmcnt(12)
    v_lshlrev_b32 v142, 16, v142
    v_lshlrev_b32 v140, 16, v140
    v_mul_f32 v142, 0x3fb8aa3b, v142
    v_lshlrev_b32 v141, 16, v141
    v_exp_f32 v142, v142
    v_max_f32 v232, |v140|, |v141|
    v_cvt_pk_bf16_f32 v142, v142, v142
    v_rcp_f32 v233, v232
    v_lshlrev_b32 v142, 16, v142
    v_mul_f32 v234, v142, v140
    v_mul_f32 v235, v142, v141
    v_mul_f32 v234, 0x3fb8aa3b, v234
    v_mul_f32 v235, 0x3e22f983, v235
    v_exp_f32 v228, v234
    v_rndne_f32 v229, v235
    v_sub_f32 v235, v235, v229
    v_cos_f32 v230, v235
    v_sin_f32 v229, v235
    v_mul_f32 v104, v228, v230
    v_mul_f32 v105, v228, v229
    v_mul_f32 v140, v140, v233
    v_mul_f32 v141, v141, v233
    v_mul_f32 v228, v140, v140
    v_fma_f32 v228, v141, v141, v228
    v_mul_f32 v228, v228, v232
    v_rcp_f32 v228, v228
    v_add_f32 v229, -1.0, v104
    v_mul_f32 v230, v229, v140
    v_fma_f32 v230, v105, v141, v230
    v_mul_f32 v231, v105, v140
    v_fma_f32 v231, -v229, v141, v231
    v_add_f32 v228, v228, v228
    v_mul_f32 v106, v230, v228
    v_mul_f32 v107, v231, v228
    s_waitcnt vmcnt(9)
    v_lshlrev_b32 v145, 16, v145
    v_lshlrev_b32 v143, 16, v143
    v_mul_f32 v145, 0x3fb8aa3b, v145
    v_lshlrev_b32 v144, 16, v144
    v_exp_f32 v145, v145
    v_max_f32 v232, |v143|, |v144|
    v_cvt_pk_bf16_f32 v145, v145, v145
    s_add_u32 m0, s58, 16384
    s_add_u32 s54, s97, 0
    buffer_load_dwordx4 v4, s[4:7], s54 offen lds
    v_rcp_f32 v233, v232
    v_lshlrev_b32 v145, 16, v145
    v_mul_f32 v236, v145, v143
    v_mul_f32 v237, v145, v144
    v_mul_f32 v236, 0x3fb8aa3b, v236
    v_mul_f32 v237, 0x3e22f983, v237
    v_exp_f32 v228, v236
    v_rndne_f32 v229, v237
    buffer_load_dwordx4 v5, s[4:7], s54 offen offset:1024 lds
    v_sub_f32 v237, v237, v229
    v_cos_f32 v230, v237
    v_sin_f32 v229, v237
    v_mul_f32 v128, v228, v230
    v_mul_f32 v129, v228, v229
    v_mul_f32 v143, v143, v233
    v_mul_f32 v144, v144, v233
    v_mul_f32 v228, v143, v143
    buffer_load_dwordx4 v6, s[4:7], s54 offen offset:2048 lds
    v_fma_f32 v228, v144, v144, v228
    v_mul_f32 v228, v228, v232
    v_rcp_f32 v228, v228
    v_add_f32 v229, -1.0, v128
    v_mul_f32 v230, v229, v143
    v_fma_f32 v230, v129, v144, v230
    v_mul_f32 v231, v129, v143
    v_fma_f32 v231, -v229, v144, v231
    buffer_load_dwordx4 v7, s[4:7], s54 offen offset:3072 lds
    v_add_f32 v228, v228, v228
    v_mul_f32 v130, v230, v228
    v_mul_f32 v131, v231, v228
    v_cmp_gt_u32 vcc, 8, v3
    v_cvt_f32_u32 v238, v2
    v_mov_b32 v228, 1.0
    v_cndmask_b32_e64 v154, v228, -1.0, vcc
    v_mul_f32 v239, 0xc2000000, v238
    s_add_u32 m0, s59, 16384
    s_nop 0
    buffer_load_dwordx4 v8, s[8:11], s54 offen lds
    v_add_f32 v239, 0x42e00000, v239
    v_mul_f32 v228, v239, v234
    v_mul_f32 v229, v239, v235
    v_exp_f32 v228, v228
    v_fract_f32 v229, v229
    v_cos_f32 v230, v229
    v_sin_f32 v229, v229
    v_mul_f32 v240, v228, v230
    buffer_load_dwordx4 v9, s[8:11], s54 offen offset:1024 lds
    v_mul_f32 v241, v228, v229
    v_mul_f32 v108, v240, v106
    v_mul_f32 v110, v240, v107
    v_fma_f32 v108, -v241, v107, v108
    v_fma_f32 v110, v241, v106, v110
    v_add_f32 v239, 0xc1800000, v239
    v_mul_f32 v228, v239, v234
    v_mul_f32 v229, v239, v235
    s_add_u32 m0, s59, 18432
    s_nop 0
    buffer_load_dwordx4 v8, s[12:15], s54 offen lds
    v_exp_f32 v228, v228
    v_fract_f32 v229, v229
    v_cos_f32 v230, v229
    v_sin_f32 v229, v229
    v_mul_f32 v240, v228, v230
    v_mul_f32 v241, v228, v229
    v_mul_f32 v109, v240, v106
    v_mul_f32 v111, v240, v107
    buffer_load_dwordx4 v9, s[12:15], s54 offen offset:1024 lds
    v_fma_f32 v109, -v241, v107, v109
    v_fma_f32 v111, v241, v106, v111
    v_cvt_f32_u32 v242, s51
    v_mul_f32 v242, 4.0, v242
    v_sub_f32 v239, v239, v242
    v_add_f32 v239, 0x41e00000, v239
    v_mul_f32 v228, v239, v236
    v_mul_f32 v229, v239, v237
    s_add_u32 m0, s60, 2048
    s_mov_b32 exec_hi, 0
    buffer_load_dwordx4 v10, s[16:19], s54 offen lds
    s_mov_b32 exec_hi, -1
    v_exp_f32 v228, v228
    v_fract_f32 v229, v229
    v_cos_f32 v230, v229
    v_sin_f32 v229, v229
    v_mul_f32 v240, v228, v230
    v_mul_f32 v241, v228, v229
    v_mul_f32 v132, v240, v130
    v_mul_f32 v134, v240, v131
    v_fma_f32 v132, -v241, v131, v132
    v_fma_f32 v134, v241, v130, v134
    v_add_f32 v239, 0xc1800000, v239
    v_mul_f32 v228, v239, v236
    v_mul_f32 v229, v239, v237
    v_exp_f32 v228, v228
    v_fract_f32 v229, v229
    s_waitcnt vmcnt(9)
    s_barrier
    ds_read_b128 a[192:195], v15 offset:0
    ds_read_b128 a[152:155], v13 offset:0
    ds_read_b128 a[196:199], v15 offset:2048
    ds_read_b128 a[156:159], v13 offset:2048
    ds_read_b128 a[160:163], v13 offset:4096
    ds_read_b128 a[164:167], v13 offset:6144
    ds_read_b128 a[168:171], v13 offset:8192
    ds_read_b128 a[172:175], v13 offset:10240
    ds_read_b128 a[176:179], v13 offset:12288
    ds_read_b128 a[180:183], v13 offset:14336
    ds_read_b128 a[200:203], v17 offset:0
    ds_read_b128 a[184:187], v19 offset:0
    ds_read_b128 a[188:191], v19 offset:2048
    s_waitcnt lgkmcnt(11)
    v_mfma_f32_16x16x32_bf16 v[32:35], a[152:155], a[192:195], 0
    ds_read_b128 a[244:247], v16 offset:0
    buffer_store_dword v160, v21, s[28:31], 0 offen sc1
    s_waitcnt lgkmcnt(11)
    v_mfma_f32_16x16x32_bf16 v[64:67], a[152:155], a[196:199], 0
    ds_read_b128 a[204:207], v14 offset:0
    global_load_ushort v156, v162, s[100:101]
    s_waitcnt lgkmcnt(11)
    v_mfma_f32_16x16x32_bf16 v[36:39], a[156:159], a[192:195], 0
    ds_read_b128 a[248:251], v16 offset:2048
    global_load_ushort v157, v162, s[100:101] offset:32
    v_mfma_f32_16x16x32_bf16 v[68:71], a[156:159], a[196:199], 0
    ds_read_b128 a[208:211], v14 offset:2048
    global_load_ushort v158, v161, s[100:101] offset:256
    s_waitcnt lgkmcnt(12)
    v_mfma_f32_16x16x32_bf16 v[40:43], a[160:163], a[192:195], 0
    ds_read_b128 a[212:215], v14 offset:4096
    s_add_u32 m0, s58, 32768
    s_add_u32 s54, s96, 128
    buffer_load_dwordx4 v4, s[4:7], s54 offen lds
    v_mfma_f32_16x16x32_bf16 v[72:75], a[160:163], a[196:199], 0
    ds_read_b128 a[216:219], v14 offset:6144
    buffer_load_dwordx4 v5, s[4:7], s54 offen offset:1024 lds
    s_waitcnt lgkmcnt(13)
    v_mfma_f32_16x16x32_bf16 v[44:47], a[164:167], a[192:195], 0
    ds_read_b128 a[220:223], v14 offset:8192
    buffer_load_dwordx4 v6, s[4:7], s54 offen offset:2048 lds
    v_mfma_f32_16x16x32_bf16 v[76:79], a[164:167], a[196:199], 0
    ds_read_b128 a[224:227], v14 offset:10240
    buffer_load_dwordx4 v7, s[4:7], s54 offen offset:3072 lds
    s_waitcnt lgkmcnt(14)
    v_mfma_f32_16x16x32_bf16 v[48:51], a[168:171], a[192:195], 0
    ds_read_b128 a[228:231], v14 offset:12288
    s_add_u32 m0, s59, 32768
    s_nop 0
    buffer_load_dwordx4 v8, s[8:11], s54 offen lds
    v_mfma_f32_16x16x32_bf16 v[80:83], a[168:171], a[196:199], 0
    ds_read_b128 a[232:235], v14 offset:14336
    buffer_load_dwordx4 v9, s[8:11], s54 offen offset:1024 lds
    s_waitcnt lgkmcnt(15)
    v_mfma_f32_16x16x32_bf16 v[52:55], a[172:175], a[192:195], 0
    ds_read_b128 a[252:255], v18 offset:0
    v_cos_f32 v230, v229
    v_mfma_f32_16x16x32_bf16 v[84:87], a[172:175], a[196:199], 0
    ds_read_b128 a[236:239], v20 offset:0
    s_add_u32 m0, s59, 34816
    s_nop 0
    buffer_load_dwordx4 v8, s[12:15], s54 offen lds
    s_waitcnt lgkmcnt(15)
    v_mfma_f32_16x16x32_bf16 v[56:59], a[176:179], a[192:195], 0
    ds_read_b128 a[240:243], v20 offset:2048
    v_sin_f32 v229, v229
    v_mfma_f32_16x16x32_bf16 v[88:91], a[176:179], a[196:199], 0
    v_mul_f32 v240, v228, v230
    v_mul_f32 v241, v228, v229
    v_mfma_f32_16x16x32_bf16 v[60:63], a[180:183], a[192:195], 0
    buffer_load_dwordx4 v9, s[12:15], s54 offen offset:1024 lds
    v_mul_f32 v133, v240, v130
    v_mfma_f32_16x16x32_bf16 v[92:95], a[180:183], a[196:199], 0
    v_mul_f32 v135, v240, v131
    v_fma_f32 v133, -v241, v131, v133
    s_waitcnt lgkmcnt(14)
    v_mfma_f32_16x16x32_bf16 v[96:99], a[184:187], a[200:203], 0
    v_fma_f32 v135, v241, v130, v135
    v_mul_f32 v134, v154, v134
    s_waitcnt lgkmcnt(13)
    v_mfma_f32_16x16x32_bf16 v[100:103], a[188:191], a[200:203], 0
    s_add_u32 m0, s60, 4096
    s_mov_b32 exec_hi, 0
    buffer_load_dwordx4 v10, s[16:19], s54 offen lds
    s_mov_b32 exec_hi, -1
    s_waitcnt lgkmcnt(0)
    s_waitcnt vmcnt(13)
    s_barrier
    v_mfma_f32_16x16x32_bf16 v[32:35], a[204:207], a[244:247], v[32:35]
    ds_read_b128 a[192:195], v15 offset:16384
    v_mul_f32 v135, v154, v135
    v_mfma_f32_16x16x32_bf16 v[64:67], a[204:207], a[248:251], v[64:67]
    ds_read_b128 a[152:155], v13 offset:16384
    v_mul_f32 v129, v154, v129
    v_mfma_f32_16x16x32_bf16 v[36:39], a[208:211], a[244:247], v[36:39]
    ds_read_b128 a[196:199], v15 offset:18432
    s_add_u32 m0, s58, 0
    s_add_u32 s54, s98, 0
    buffer_load_dwordx4 v4, s[4:7], s54 offen lds
    v_mfma_f32_16x16x32_bf16 v[68:71], a[208:211], a[248:251], v[68:71]
    ds_read_b128 a[156:159], v13 offset:18432
    v_mul_f32 v131, v154, v131
    v_mfma_f32_16x16x32_bf16 v[40:43], a[212:215], a[244:247], v[40:43]
    ds_read_b128 a[160:163], v13 offset:20480
    v_mul_f32 v228, 0x41800000, v234
    v_mfma_f32_16x16x32_bf16 v[72:75], a[212:215], a[248:251], v[72:75]
    ds_read_b128 a[164:167], v13 offset:22528
    buffer_load_dwordx4 v5, s[4:7], s54 offen offset:1024 lds
    v_mfma_f32_16x16x32_bf16 v[44:47], a[216:219], a[244:247], v[44:47]
    ds_read_b128 a[168:171], v13 offset:24576
    v_mul_f32 v229, 0x41800000, v235
    v_mfma_f32_16x16x32_bf16 v[76:79], a[216:219], a[248:251], v[76:79]
    ds_read_b128 a[172:175], v13 offset:26624
    v_exp_f32 v228, v228
    v_mfma_f32_16x16x32_bf16 v[48:51], a[220:223], a[244:247], v[48:51]
    ds_read_b128 a[176:179], v13 offset:28672
    buffer_load_dwordx4 v6, s[4:7], s54 offen offset:2048 lds
    v_mfma_f32_16x16x32_bf16 v[80:83], a[220:223], a[248:251], v[80:83]
    ds_read_b128 a[180:183], v13 offset:30720
    v_fract_f32 v229, v229
    v_mfma_f32_16x16x32_bf16 v[52:55], a[224:227], a[244:247], v[52:55]
    ds_read_b128 a[200:203], v17 offset:2048
    v_cos_f32 v230, v229
    v_mfma_f32_16x16x32_bf16 v[84:87], a[224:227], a[248:251], v[84:87]
    ds_read_b128 a[184:187], v19 offset:16384
    buffer_load_dwordx4 v7, s[4:7], s54 offen offset:3072 lds
    v_mfma_f32_16x16x32_bf16 v[56:59], a[228:231], a[244:247], v[56:59]
    ds_read_b128 a[188:191], v19 offset:18432
    v_sin_f32 v229, v229
    v_mfma_f32_16x16x32_bf16 v[88:91], a[228:231], a[248:251], v[88:91]
    v_mul_f32 v120, v228, v230
    v_mul_f32 v121, v228, v229
    v_mfma_f32_16x16x32_bf16 v[60:63], a[232:235], a[244:247], v[60:63]
    s_add_u32 m0, s59, 0
    s_nop 0
    buffer_load_dwordx4 v8, s[8:11], s54 offen lds
    v_mfma_f32_16x16x32_bf16 v[92:95], a[232:235], a[248:251], v[92:95]
    v_mul_f32 v228, 0x42000000, v234
    v_mul_f32 v229, 0x42000000, v235
    v_mfma_f32_16x16x32_bf16 v[96:99], a[236:239], a[252:255], v[96:99]
    v_mfma_f32_16x16x32_bf16 v[100:103], a[240:243], a[252:255], v[100:103]
    s_waitcnt lgkmcnt(0)
    v_mfma_f32_16x16x32_bf16 v[32:35], a[152:155], a[192:195], v[32:35]
    ds_read_b128 a[244:247], v16 offset:16384
    v_exp_f32 v228, v228
    v_mfma_f32_16x16x32_bf16 v[64:67], a[152:155], a[196:199], v[64:67]
    ds_read_b128 a[204:207], v14 offset:16384
    v_fract_f32 v229, v229
    v_mfma_f32_16x16x32_bf16 v[36:39], a[156:159], a[192:195], v[36:39]
    ds_read_b128 a[248:251], v16 offset:18432
    buffer_load_dwordx4 v9, s[8:11], s54 offen offset:1024 lds
    v_mfma_f32_16x16x32_bf16 v[68:71], a[156:159], a[196:199], v[68:71]
    ds_read_b128 a[208:211], v14 offset:18432
    v_cos_f32 v230, v229
    v_mfma_f32_16x16x32_bf16 v[40:43], a[160:163], a[192:195], v[40:43]
    ds_read_b128 a[212:215], v14 offset:20480
    v_sin_f32 v229, v229
    v_mfma_f32_16x16x32_bf16 v[72:75], a[160:163], a[196:199], v[72:75]
    ds_read_b128 a[216:219], v14 offset:22528
    s_add_u32 m0, s59, 2048
    s_nop 0
    buffer_load_dwordx4 v8, s[12:15], s54 offen lds
    v_mfma_f32_16x16x32_bf16 v[44:47], a[164:167], a[192:195], v[44:47]
    ds_read_b128 a[220:223], v14 offset:24576
    v_mul_f32 v122, v228, v230
    v_mfma_f32_16x16x32_bf16 v[76:79], a[164:167], a[196:199], v[76:79]
    ds_read_b128 a[224:227], v14 offset:26624
    v_mul_f32 v123, v228, v229
    v_mfma_f32_16x16x32_bf16 v[48:51], a[168:171], a[192:195], v[48:51]
    ds_read_b128 a[228:231], v14 offset:28672
    buffer_load_dwordx4 v9, s[12:15], s54 offen offset:1024 lds
    v_mfma_f32_16x16x32_bf16 v[80:83], a[168:171], a[196:199], v[80:83]
    ds_read_b128 a[232:235], v14 offset:30720
    v_mul_f32 v228, 0x41800000, v236
    v_mfma_f32_16x16x32_bf16 v[52:55], a[172:175], a[192:195], v[52:55]
    ds_read_b128 a[252:255], v18 offset:2048
    v_mul_f32 v229, 0x41800000, v237
    v_mfma_f32_16x16x32_bf16 v[84:87], a[172:175], a[196:199], v[84:87]
    ds_read_b128 a[236:239], v20 offset:16384
    s_add_u32 m0, s60, 0
    s_mov_b32 exec_hi, 0
    buffer_load_dwordx4 v10, s[16:19], s54 offen lds
    s_mov_b32 exec_hi, -1
    v_mfma_f32_16x16x32_bf16 v[56:59], a[176:179], a[192:195], v[56:59]
    ds_read_b128 a[240:243], v20 offset:18432
    v_exp_f32 v228, v228
    v_mfma_f32_16x16x32_bf16 v[88:91], a[176:179], a[196:199], v[88:91]
    v_fract_f32 v229, v229
    v_cos_f32 v230, v229
    v_mfma_f32_16x16x32_bf16 v[60:63], a[180:183], a[192:195], v[60:63]
    v_sin_f32 v229, v229
    v_mfma_f32_16x16x32_bf16 v[92:95], a[180:183], a[196:199], v[92:95]
    v_mul_f32 v144, v228, v230
    v_mfma_f32_16x16x32_bf16 v[96:99], a[184:187], a[200:203], v[96:99]
    v_mfma_f32_16x16x32_bf16 v[100:103], a[188:191], a[200:203], v[100:103]
    s_waitcnt lgkmcnt(0)
    s_waitcnt vmcnt(9)
    s_barrier
    v_mfma_f32_16x16x32_bf16 v[32:35], a[204:207], a[244:247], v[32:35]
    ds_read_b128 a[192:195], v15 offset:32768
    v_mul_f32 v145, v228, v229
    v_mfma_f32_16x16x32_bf16 v[64:67], a[204:207], a[248:251], v[64:67]
    ds_read_b128 a[152:155], v13 offset:32768
    v_mul_f32 v228, 0x42000000, v236
    v_mfma_f32_16x16x32_bf16 v[36:39], a[208:211], a[244:247], v[36:39]
    ds_read_b128 a[196:199], v15 offset:34816
    s_add_u32 m0, s58, 16384
    s_add_u32 s54, s97, 128
    buffer_load_dwordx4 v4, s[4:7], s54 offen lds
    v_mfma_f32_16x16x32_bf16 v[68:71], a[208:211], a[248:251], v[68:71]
    ds_read_b128 a[156:159], v13 offset:34816
    v_mul_f32 v229, 0x42000000, v237
    v_mfma_f32_16x16x32_bf16 v[40:43], a[212:215], a[244:247], v[40:43]
    ds_read_b128 a[160:163], v13 offset:36864
    v_exp_f32 v228, v228
    v_mfma_f32_16x16x32_bf16 v[72:75], a[212:215], a[248:251], v[72:75]
    ds_read_b128 a[164:167], v13 offset:38912
    buffer_load_dwordx4 v5, s[4:7], s54 offen offset:1024 lds
    v_mfma_f32_16x16x32_bf16 v[44:47], a[216:219], a[244:247], v[44:47]
    ds_read_b128 a[168:171], v13 offset:40960
    v_fract_f32 v229, v229
    v_mfma_f32_16x16x32_bf16 v[76:79], a[216:219], a[248:251], v[76:79]
    ds_read_b128 a[172:175], v13 offset:43008
    v_cos_f32 v230, v229
    v_mfma_f32_16x16x32_bf16 v[48:51], a[220:223], a[244:247], v[48:51]
    ds_read_b128 a[176:179], v13 offset:45056
    buffer_load_dwordx4 v6, s[4:7], s54 offen offset:2048 lds
    v_mfma_f32_16x16x32_bf16 v[80:83], a[220:223], a[248:251], v[80:83]
    ds_read_b128 a[180:183], v13 offset:47104
    v_sin_f32 v229, v229
    v_mfma_f32_16x16x32_bf16 v[52:55], a[224:227], a[244:247], v[52:55]
    ds_read_b128 a[200:203], v17 offset:4096
    v_mul_f32 v146, v228, v230
    v_mfma_f32_16x16x32_bf16 v[84:87], a[224:227], a[248:251], v[84:87]
    ds_read_b128 a[184:187], v19 offset:32768
    buffer_load_dwordx4 v7, s[4:7], s54 offen offset:3072 lds
    v_mfma_f32_16x16x32_bf16 v[56:59], a[228:231], a[244:247], v[56:59]
    ds_read_b128 a[188:191], v19 offset:34816
    v_mul_f32 v147, v228, v229
    v_mfma_f32_16x16x32_bf16 v[88:91], a[228:231], a[248:251], v[88:91]
    v_mul_f32 v228, 4.0, v236
    v_mul_f32 v229, 4.0, v237
    v_mfma_f32_16x16x32_bf16 v[60:63], a[232:235], a[244:247], v[60:63]
    s_add_u32 m0, s59, 16384
    s_nop 0
    buffer_load_dwordx4 v8, s[8:11], s54 offen lds
    v_mfma_f32_16x16x32_bf16 v[92:95], a[232:235], a[248:251], v[92:95]
    v_exp_f32 v228, v228
    v_mfma_f32_16x16x32_bf16 v[96:99], a[236:239], a[252:255], v[96:99]
    v_fract_f32 v229, v229
    v_mfma_f32_16x16x32_bf16 v[100:103], a[240:243], a[252:255], v[100:103]
    s_waitcnt lgkmcnt(0)
    v_mfma_f32_16x16x32_bf16 v[32:35], a[152:155], a[192:195], v[32:35]
    ds_read_b128 a[244:247], v16 offset:32768
    v_cos_f32 v230, v229
    v_mfma_f32_16x16x32_bf16 v[64:67], a[152:155], a[196:199], v[64:67]
    ds_read_b128 a[204:207], v14 offset:32768
    v_sin_f32 v229, v229
    v_mfma_f32_16x16x32_bf16 v[36:39], a[156:159], a[192:195], v[36:39]
    ds_read_b128 a[248:251], v16 offset:34816
    buffer_load_dwordx4 v9, s[8:11], s54 offen offset:1024 lds
    v_mfma_f32_16x16x32_bf16 v[68:71], a[156:159], a[196:199], v[68:71]
    ds_read_b128 a[208:211], v14 offset:34816
    v_mul_f32 v148, v228, v230
    v_mfma_f32_16x16x32_bf16 v[40:43], a[160:163], a[192:195], v[40:43]
    ds_read_b128 a[212:215], v14 offset:36864
    v_mul_f32 v149, v228, v229
    v_mfma_f32_16x16x32_bf16 v[72:75], a[160:163], a[196:199], v[72:75]
    ds_read_b128 a[216:219], v14 offset:38912
    s_add_u32 m0, s59, 18432
    s_nop 0
    buffer_load_dwordx4 v8, s[12:15], s54 offen lds
    v_mfma_f32_16x16x32_bf16 v[44:47], a[164:167], a[192:195], v[44:47]
    ds_read_b128 a[220:223], v14 offset:40960
    v_mul_f32 v228, v242, v236
    v_mfma_f32_16x16x32_bf16 v[76:79], a[164:167], a[196:199], v[76:79]
    ds_read_b128 a[224:227], v14 offset:43008
    v_mul_f32 v229, v242, v237
    v_mfma_f32_16x16x32_bf16 v[48:51], a[168:171], a[192:195], v[48:51]
    ds_read_b128 a[228:231], v14 offset:45056
    buffer_load_dwordx4 v9, s[12:15], s54 offen offset:1024 lds
    v_mfma_f32_16x16x32_bf16 v[80:83], a[168:171], a[196:199], v[80:83]
    ds_read_b128 a[232:235], v14 offset:47104
    v_exp_f32 v228, v228
    v_mfma_f32_16x16x32_bf16 v[52:55], a[172:175], a[192:195], v[52:55]
    ds_read_b128 a[252:255], v18 offset:4096
    v_fract_f32 v229, v229
    v_mfma_f32_16x16x32_bf16 v[84:87], a[172:175], a[196:199], v[84:87]
    ds_read_b128 a[236:239], v20 offset:32768
    s_add_u32 m0, s60, 2048
    s_mov_b32 exec_hi, 0
    buffer_load_dwordx4 v10, s[16:19], s54 offen lds
    s_mov_b32 exec_hi, -1
    v_mfma_f32_16x16x32_bf16 v[56:59], a[176:179], a[192:195], v[56:59]
    ds_read_b128 a[240:243], v20 offset:34816
    v_cos_f32 v230, v229
    v_mfma_f32_16x16x32_bf16 v[88:91], a[176:179], a[196:199], v[88:91]
    v_sin_f32 v229, v229
    v_mfma_f32_16x16x32_bf16 v[60:63], a[180:183], a[192:195], v[60:63]
    s_mov_b64 exec, 1
    buffer_atomic_add v250, v249, s[36:39], 0 offen sc1
    s_mov_b64 exec, -1
    v_mfma_f32_16x16x32_bf16 v[92:95], a[180:183], a[196:199], v[92:95]
    v_mul_f32 v150, v228, v230
    v_mul_f32 v151, v228, v229
    v_mfma_f32_16x16x32_bf16 v[96:99], a[184:187], a[200:203], v[96:99]
    v_mul_f32 v145, v154, v145
    v_mfma_f32_16x16x32_bf16 v[100:103], a[188:191], a[200:203], v[100:103]
    s_waitcnt lgkmcnt(0)
    s_waitcnt vmcnt(10)
    s_barrier
    v_mfma_f32_16x16x32_bf16 v[32:35], a[204:207], a[244:247], v[32:35]
    ds_read_b128 a[192:195], v15 offset:0
    v_mul_f32 v147, v154, v147
    v_mfma_f32_16x16x32_bf16 v[64:67], a[204:207], a[248:251], v[64:67]
    ds_read_b128 a[152:155], v13 offset:0
    v_mul_f32 v149, v154, v149
    v_mfma_f32_16x16x32_bf16 v[36:39], a[208:211], a[244:247], v[36:39]
    ds_read_b128 a[196:199], v15 offset:2048
    s_add_u32 m0, s58, 32768
    s_add_u32 s54, s96, 256
    buffer_load_dwordx4 v4, s[4:7], s54 offen lds
    v_mfma_f32_16x16x32_bf16 v[68:71], a[208:211], a[248:251], v[68:71]
    ds_read_b128 a[156:159], v13 offset:2048
    v_mul_f32 v151, v154, v151
    v_mfma_f32_16x16x32_bf16 v[40:43], a[212:215], a[244:247], v[40:43]
    ds_read_b128 a[160:163], v13 offset:4096
    v_cmp_eq_u32 vcc, 3, v2
    v_mfma_f32_16x16x32_bf16 v[72:75], a[212:215], a[248:251], v[72:75]
    ds_read_b128 a[164:167], v13 offset:6144
    buffer_load_dwordx4 v5, s[4:7], s54 offen offset:1024 lds
    v_mfma_f32_16x16x32_bf16 v[44:47], a[216:219], a[244:247], v[44:47]
    ds_read_b128 a[168:171], v13 offset:8192
    v_and_b32 v228, 1, v2
    v_mfma_f32_16x16x32_bf16 v[76:79], a[216:219], a[248:251], v[76:79]
    ds_read_b128 a[172:175], v13 offset:10240
    v_cvt_f32_u32 v126, v228
    v_mfma_f32_16x16x32_bf16 v[48:51], a[220:223], a[244:247], v[48:51]
    ds_read_b128 a[176:179], v13 offset:12288
    buffer_load_dwordx4 v6, s[4:7], s54 offen offset:2048 lds
    v_mfma_f32_16x16x32_bf16 v[80:83], a[220:223], a[248:251], v[80:83]
    ds_read_b128 a[180:183], v13 offset:14336
    v_cndmask_b32 v125, 0, v123, vcc
    v_mfma_f32_16x16x32_bf16 v[52:55], a[224:227], a[244:247], v[52:55]
    ds_read_b128 a[200:203], v17 offset:0
    v_cndmask_b32 v153, 0, v147, vcc
    v_mfma_f32_16x16x32_bf16 v[84:87], a[224:227], a[248:251], v[84:87]
    ds_read_b128 a[184:187], v19 offset:0
    buffer_load_dwordx4 v7, s[4:7], s54 offen offset:3072 lds
    v_mfma_f32_16x16x32_bf16 v[56:59], a[228:231], a[244:247], v[56:59]
    ds_read_b128 a[188:191], v19 offset:2048
    v_cndmask_b32 v124, 1.0, v122, vcc
    v_mfma_f32_16x16x32_bf16 v[88:91], a[228:231], a[248:251], v[88:91]
    v_cndmask_b32 v152, 1.0, v146, vcc
    v_cmp_lt_u32 vcc, 1, v2
    v_mfma_f32_16x16x32_bf16 v[60:63], a[232:235], a[244:247], v[60:63]
    s_add_u32 m0, s59, 32768
    s_nop 0
    buffer_load_dwordx4 v8, s[8:11], s54 offen lds
    v_mfma_f32_16x16x32_bf16 v[92:95], a[232:235], a[248:251], v[92:95]
    v_mul_f32 v239, 0x43000000, v238
    v_nop
    v_mfma_f32_16x16x32_bf16 v[96:99], a[236:239], a[252:255], v[96:99]
    v_mfma_f32_16x16x32_bf16 v[100:103], a[240:243], a[252:255], v[100:103]
    s_waitcnt lgkmcnt(0)
    v_mfma_f32_16x16x32_bf16 v[32:35], a[152:155], a[192:195], v[32:35]
    ds_read_b128 a[244:247], v16 offset:0
    v_cndmask_b32 v124, 0, v124, vcc
    v_mfma_f32_16x16x32_bf16 v[64:67], a[152:155], a[196:199], v[64:67]
    ds_read_b128 a[204:207], v14 offset:0
    v_cndmask_b32 v152, 0, v152, vcc
    v_mfma_f32_16x16x32_bf16 v[36:39], a[156:159], a[192:195], v[36:39]
    ds_read_b128 a[248:251], v16 offset:2048
    buffer_load_dwordx4 v9, s[8:11], s54 offen offset:1024 lds
    v_mfma_f32_16x16x32_bf16 v[68:71], a[156:159], a[196:199], v[68:71]
    ds_read_b128 a[208:211], v14 offset:2048
    v_mul_f32 v228, v239, v234
    v_mfma_f32_16x16x32_bf16 v[40:43], a[160:163], a[192:195], v[40:43]
    ds_read_b128 a[212:215], v14 offset:4096
    v_mul_f32 v229, v239, v235
    v_mfma_f32_16x16x32_bf16 v[72:75], a[160:163], a[196:199], v[72:75]
    ds_read_b128 a[216:219], v14 offset:6144
    s_add_u32 m0, s59, 34816
    s_nop 0
    buffer_load_dwordx4 v8, s[12:15], s54 offen lds
    v_mfma_f32_16x16x32_bf16 v[44:47], a[164:167], a[192:195], v[44:47]
    ds_read_b128 a[220:223], v14 offset:8192
    v_exp_f32 v228, v228
    v_mfma_f32_16x16x32_bf16 v[76:79], a[164:167], a[196:199], v[76:79]
    ds_read_b128 a[224:227], v14 offset:10240
    v_fract_f32 v229, v229
    v_mfma_f32_16x16x32_bf16 v[48:51], a[168:171], a[192:195], v[48:51]
    ds_read_b128 a[228:231], v14 offset:12288
    buffer_load_dwordx4 v9, s[12:15], s54 offen offset:1024 lds
    v_mfma_f32_16x16x32_bf16 v[80:83], a[168:171], a[196:199], v[80:83]
    ds_read_b128 a[232:235], v14 offset:14336
    v_cos_f32 v230, v229
    v_mfma_f32_16x16x32_bf16 v[52:55], a[172:175], a[192:195], v[52:55]
    ds_read_b128 a[252:255], v18 offset:0
    v_sin_f32 v229, v229
    v_mfma_f32_16x16x32_bf16 v[84:87], a[172:175], a[196:199], v[84:87]
    ds_read_b128 a[236:239], v20 offset:0
    s_add_u32 m0, s60, 4096
    s_mov_b32 exec_hi, 0
    buffer_load_dwordx4 v10, s[16:19], s54 offen lds
    s_mov_b32 exec_hi, -1
    v_mfma_f32_16x16x32_bf16 v[56:59], a[176:179], a[192:195], v[56:59]
    ds_read_b128 a[240:243], v20 offset:2048
    v_mul_f32 v114, v228, v230
    v_mfma_f32_16x16x32_bf16 v[88:91], a[176:179], a[196:199], v[88:91]
    v_mul_f32 v115, v228, v229
    v_mul_f32 v228, v239, v236
    v_mfma_f32_16x16x32_bf16 v[60:63], a[180:183], a[192:195], v[60:63]
    s_mov_b64 exec, 2
    buffer_atomic_add v250, v249, s[36:39], 0 offen sc1
    s_mov_b64 exec, -1
    v_mfma_f32_16x16x32_bf16 v[92:95], a[180:183], a[196:199], v[92:95]
    v_mul_f32 v229, v239, v237
    v_exp_f32 v228, v228
    v_mfma_f32_16x16x32_bf16 v[96:99], a[184:187], a[200:203], v[96:99]
    v_mfma_f32_16x16x32_bf16 v[100:103], a[188:191], a[200:203], v[100:103]
    s_waitcnt lgkmcnt(0)
    s_waitcnt vmcnt(11)
    s_barrier
    v_mfma_f32_16x16x32_bf16 v[32:35], a[204:207], a[244:247], v[32:35]
    ds_read_b128 a[192:195], v15 offset:16384
    v_fract_f32 v229, v229
    v_mfma_f32_16x16x32_bf16 v[64:67], a[204:207], a[248:251], v[64:67]
    ds_read_b128 a[152:155], v13 offset:16384
    v_cos_f32 v230, v229
    v_mfma_f32_16x16x32_bf16 v[36:39], a[208:211], a[244:247], v[36:39]
    ds_read_b128 a[196:199], v15 offset:18432
    s_add_u32 m0, s58, 0
    s_add_u32 s54, s98, 128
    buffer_load_dwordx4 v4, s[4:7], s54 offen lds
    v_mfma_f32_16x16x32_bf16 v[68:71], a[208:211], a[248:251], v[68:71]
    ds_read_b128 a[156:159], v13 offset:18432
    v_sin_f32 v229, v229
    v_mfma_f32_16x16x32_bf16 v[40:43], a[212:215], a[244:247], v[40:43]
    ds_read_b128 a[160:163], v13 offset:20480
    v_mul_f32 v138, v228, v230
    v_mfma_f32_16x16x32_bf16 v[72:75], a[212:215], a[248:251], v[72:75]
    ds_read_b128 a[164:167], v13 offset:22528
    buffer_load_dwordx4 v5, s[4:7], s54 offen offset:1024 lds
    v_mfma_f32_16x16x32_bf16 v[44:47], a[216:219], a[244:247], v[44:47]
    ds_read_b128 a[168:171], v13 offset:24576
    v_mul_f32 v139, v228, v229
    v_mfma_f32_16x16x32_bf16 v[76:79], a[216:219], a[248:251], v[76:79]
    ds_read_b128 a[172:175], v13 offset:26624
    v_mul_f32 v228, 0x44000000, v234
    v_mfma_f32_16x16x32_bf16 v[48:51], a[220:223], a[244:247], v[48:51]
    ds_read_b128 a[176:179], v13 offset:28672
    buffer_load_dwordx4 v6, s[4:7], s54 offen offset:2048 lds
    v_mfma_f32_16x16x32_bf16 v[80:83], a[220:223], a[248:251], v[80:83]
    ds_read_b128 a[180:183], v13 offset:30720
    v_mul_f32 v229, 0x44000000, v235
    v_mfma_f32_16x16x32_bf16 v[52:55], a[224:227], a[244:247], v[52:55]
    ds_read_b128 a[200:203], v17 offset:2048
    v_exp_f32 v228, v228
    v_mfma_f32_16x16x32_bf16 v[84:87], a[224:227], a[248:251], v[84:87]
    ds_read_b128 a[184:187], v19 offset:16384
    buffer_load_dwordx4 v7, s[4:7], s54 offen offset:3072 lds
    v_mfma_f32_16x16x32_bf16 v[56:59], a[228:231], a[244:247], v[56:59]
    ds_read_b128 a[188:191], v19 offset:18432
    v_fract_f32 v229, v229
    v_mfma_f32_16x16x32_bf16 v[88:91], a[228:231], a[248:251], v[88:91]
    v_cos_f32 v230, v229
    v_mfma_f32_16x16x32_bf16 v[60:63], a[232:235], a[244:247], v[60:63]
    s_add_u32 m0, s59, 0
    s_nop 0
    buffer_load_dwordx4 v8, s[8:11], s54 offen lds
    v_mfma_f32_16x16x32_bf16 v[92:95], a[232:235], a[248:251], v[92:95]
    v_sin_f32 v229, v229
    v_mfma_f32_16x16x32_bf16 v[96:99], a[236:239], a[252:255], v[96:99]
    v_mul_f32 v112, v228, v230
    v_mul_f32 v113, v228, v229
    v_mfma_f32_16x16x32_bf16 v[100:103], a[240:243], a[252:255], v[100:103]
    s_waitcnt lgkmcnt(0)
    v_mfma_f32_16x16x32_bf16 v[32:35], a[152:155], a[192:195], v[32:35]
    ds_read_b128 a[244:247], v16 offset:16384
    v_mul_f32 v228, 0x44000000, v236
    v_mfma_f32_16x16x32_bf16 v[64:67], a[152:155], a[196:199], v[64:67]
    ds_read_b128 a[204:207], v14 offset:16384
    v_mul_f32 v229, 0x44000000, v237
    v_mfma_f32_16x16x32_bf16 v[36:39], a[156:159], a[192:195], v[36:39]
    ds_read_b128 a[248:251], v16 offset:18432
    buffer_load_dwordx4 v9, s[8:11], s54 offen offset:1024 lds
    v_mfma_f32_16x16x32_bf16 v[68:71], a[156:159], a[196:199], v[68:71]
    ds_read_b128 a[208:211], v14 offset:18432
    v_exp_f32 v228, v228
    v_mfma_f32_16x16x32_bf16 v[40:43], a[160:163], a[192:195], v[40:43]
    ds_read_b128 a[212:215], v14 offset:20480
    v_fract_f32 v229, v229
    v_mfma_f32_16x16x32_bf16 v[72:75], a[160:163], a[196:199], v[72:75]
    ds_read_b128 a[216:219], v14 offset:22528
    s_add_u32 m0, s59, 2048
    s_nop 0
    buffer_load_dwordx4 v8, s[12:15], s54 offen lds
    v_mfma_f32_16x16x32_bf16 v[44:47], a[164:167], a[192:195], v[44:47]
    ds_read_b128 a[220:223], v14 offset:24576
    v_cos_f32 v230, v229
    v_mfma_f32_16x16x32_bf16 v[76:79], a[164:167], a[196:199], v[76:79]
    ds_read_b128 a[224:227], v14 offset:26624
    v_sin_f32 v229, v229
    v_mfma_f32_16x16x32_bf16 v[48:51], a[168:171], a[192:195], v[48:51]
    ds_read_b128 a[228:231], v14 offset:28672
    buffer_load_dwordx4 v9, s[12:15], s54 offen offset:1024 lds
    v_mfma_f32_16x16x32_bf16 v[80:83], a[168:171], a[196:199], v[80:83]
    ds_read_b128 a[232:235], v14 offset:30720
    v_mul_f32 v136, v228, v230
    v_mfma_f32_16x16x32_bf16 v[52:55], a[172:175], a[192:195], v[52:55]
    ds_read_b128 a[252:255], v18 offset:2048
    v_mul_f32 v137, v228, v229
    v_mfma_f32_16x16x32_bf16 v[84:87], a[172:175], a[196:199], v[84:87]
    ds_read_b128 a[236:239], v20 offset:16384
    s_add_u32 m0, s60, 0
    s_mov_b32 exec_hi, 0
    buffer_load_dwordx4 v10, s[16:19], s54 offen lds
    s_mov_b32 exec_hi, -1
    v_mfma_f32_16x16x32_bf16 v[56:59], a[176:179], a[192:195], v[56:59]
    ds_read_b128 a[240:243], v20 offset:18432
    v_mul_f32 v239, 0x42000000, v238
    v_mfma_f32_16x16x32_bf16 v[88:91], a[176:179], a[196:199], v[88:91]
    v_mul_f32 v228, v239, v234
    v_mul_f32 v229, v239, v235
    v_mfma_f32_16x16x32_bf16 v[60:63], a[180:183], a[192:195], v[60:63]
    s_mov_b64 exec, 4
    buffer_atomic_add v250, v249, s[36:39], 0 offen sc1
    s_mov_b64 exec, -1
    v_mfma_f32_16x16x32_bf16 v[92:95], a[180:183], a[196:199], v[92:95]
    v_exp_f32 v228, v228
    v_mfma_f32_16x16x32_bf16 v[96:99], a[184:187], a[200:203], v[96:99]
    v_fract_f32 v229, v229
    v_mfma_f32_16x16x32_bf16 v[100:103], a[188:191], a[200:203], v[100:103]
    s_waitcnt lgkmcnt(0)
    s_waitcnt vmcnt(11)
    s_barrier
    v_mfma_f32_16x16x32_bf16 v[32:35], a[204:207], a[244:247], v[32:35]
    ds_read_b128 a[192:195], v15 offset:32768
    v_cos_f32 v230, v229
    v_mfma_f32_16x16x32_bf16 v[64:67], a[204:207], a[248:251], v[64:67]
    ds_read_b128 a[152:155], v13 offset:32768
    v_sin_f32 v229, v229
    v_mfma_f32_16x16x32_bf16 v[36:39], a[208:211], a[244:247], v[36:39]
    ds_read_b128 a[196:199], v15 offset:34816
    s_add_u32 m0, s58, 16384
    s_add_u32 s54, s97, 256
    buffer_load_dwordx4 v4, s[4:7], s54 offen lds
    v_mfma_f32_16x16x32_bf16 v[68:71], a[208:211], a[248:251], v[68:71]
    ds_read_b128 a[156:159], v13 offset:34816
    v_mul_f32 v116, v228, v230
    v_mfma_f32_16x16x32_bf16 v[40:43], a[212:215], a[244:247], v[40:43]
    ds_read_b128 a[160:163], v13 offset:36864
    v_mul_f32 v118, v228, v229
    v_mfma_f32_16x16x32_bf16 v[72:75], a[212:215], a[248:251], v[72:75]
    ds_read_b128 a[164:167], v13 offset:38912
    buffer_load_dwordx4 v5, s[4:7], s54 offen offset:1024 lds
    v_mfma_f32_16x16x32_bf16 v[44:47], a[216:219], a[244:247], v[44:47]
    ds_read_b128 a[168:171], v13 offset:40960
    v_add_f32 v239, 0x41800000, v239
    v_mfma_f32_16x16x32_bf16 v[76:79], a[216:219], a[248:251], v[76:79]
    ds_read_b128 a[172:175], v13 offset:43008
    v_mul_f32 v228, v239, v234
    v_mfma_f32_16x16x32_bf16 v[48:51], a[220:223], a[244:247], v[48:51]
    ds_read_b128 a[176:179], v13 offset:45056
    buffer_load_dwordx4 v6, s[4:7], s54 offen offset:2048 lds
    v_mfma_f32_16x16x32_bf16 v[80:83], a[220:223], a[248:251], v[80:83]
    ds_read_b128 a[180:183], v13 offset:47104
    v_mul_f32 v229, v239, v235
    v_mfma_f32_16x16x32_bf16 v[52:55], a[224:227], a[244:247], v[52:55]
    ds_read_b128 a[200:203], v17 offset:4096
    v_exp_f32 v228, v228
    v_mfma_f32_16x16x32_bf16 v[84:87], a[224:227], a[248:251], v[84:87]
    ds_read_b128 a[184:187], v19 offset:32768
    buffer_load_dwordx4 v7, s[4:7], s54 offen offset:3072 lds
    v_mfma_f32_16x16x32_bf16 v[56:59], a[228:231], a[244:247], v[56:59]
    ds_read_b128 a[188:191], v19 offset:34816
    v_fract_f32 v229, v229
    v_mfma_f32_16x16x32_bf16 v[88:91], a[228:231], a[248:251], v[88:91]
    v_cos_f32 v230, v229
    v_mfma_f32_16x16x32_bf16 v[60:63], a[232:235], a[244:247], v[60:63]
    s_add_u32 m0, s59, 16384
    s_nop 0
    buffer_load_dwordx4 v8, s[8:11], s54 offen lds
    v_mfma_f32_16x16x32_bf16 v[92:95], a[232:235], a[248:251], v[92:95]
    v_sin_f32 v229, v229
    v_mfma_f32_16x16x32_bf16 v[96:99], a[236:239], a[252:255], v[96:99]
    v_mul_f32 v117, v228, v230
    v_mul_f32 v119, v228, v229
    v_mfma_f32_16x16x32_bf16 v[100:103], a[240:243], a[252:255], v[100:103]
    s_waitcnt lgkmcnt(0)
    v_mfma_f32_16x16x32_bf16 v[32:35], a[152:155], a[192:195], v[32:35]
    ds_read_b128 a[244:247], v16 offset:32768
    v_add_f32 v239, v239, v242
    v_mfma_f32_16x16x32_bf16 v[64:67], a[152:155], a[196:199], v[64:67]
    ds_read_b128 a[204:207], v14 offset:32768
    v_cmp_gt_u32 vcc, 8, v3
    v_mfma_f32_16x16x32_bf16 v[36:39], a[156:159], a[192:195], v[36:39]
    ds_read_b128 a[248:251], v16 offset:34816
    buffer_load_dwordx4 v9, s[8:11], s54 offen offset:1024 lds
    v_mfma_f32_16x16x32_bf16 v[68:71], a[156:159], a[196:199], v[68:71]
    ds_read_b128 a[208:211], v14 offset:34816
    v_mul_f32 v228, v239, v236
    v_mfma_f32_16x16x32_bf16 v[40:43], a[160:163], a[192:195], v[40:43]
    ds_read_b128 a[212:215], v14 offset:36864
    v_mul_f32 v229, v239, v237
    v_mfma_f32_16x16x32_bf16 v[72:75], a[160:163], a[196:199], v[72:75]
    ds_read_b128 a[216:219], v14 offset:38912
    s_add_u32 m0, s59, 18432
    s_nop 0
    buffer_load_dwordx4 v8, s[12:15], s54 offen lds
    v_mfma_f32_16x16x32_bf16 v[44:47], a[164:167], a[192:195], v[44:47]
    ds_read_b128 a[220:223], v14 offset:40960
    v_exp_f32 v228, v228
    v_mfma_f32_16x16x32_bf16 v[76:79], a[164:167], a[196:199], v[76:79]
    ds_read_b128 a[224:227], v14 offset:43008
    v_fract_f32 v229, v229
    v_mfma_f32_16x16x32_bf16 v[48:51], a[168:171], a[192:195], v[48:51]
    ds_read_b128 a[228:231], v14 offset:45056
    buffer_load_dwordx4 v9, s[12:15], s54 offen offset:1024 lds
    v_mfma_f32_16x16x32_bf16 v[80:83], a[168:171], a[196:199], v[80:83]
    ds_read_b128 a[232:235], v14 offset:47104
    v_cos_f32 v230, v229
    v_mfma_f32_16x16x32_bf16 v[52:55], a[172:175], a[192:195], v[52:55]
    ds_read_b128 a[252:255], v18 offset:4096
    v_sin_f32 v229, v229
    v_mfma_f32_16x16x32_bf16 v[84:87], a[172:175], a[196:199], v[84:87]
    ds_read_b128 a[236:239], v20 offset:32768
    s_add_u32 m0, s60, 2048
    s_mov_b32 exec_hi, 0
    buffer_load_dwordx4 v10, s[16:19], s54 offen lds
    s_mov_b32 exec_hi, -1
    v_mfma_f32_16x16x32_bf16 v[56:59], a[176:179], a[192:195], v[56:59]
    ds_read_b128 a[240:243], v20 offset:34816
    v_mul_f32 v240, v228, v230
    v_mfma_f32_16x16x32_bf16 v[88:91], a[176:179], a[196:199], v[88:91]
    v_mul_f32 v241, v228, v229
    v_cndmask_b32 v141, v241, v240, vcc
    v_mfma_f32_16x16x32_bf16 v[60:63], a[180:183], a[192:195], v[60:63]
    s_mov_b64 exec, 8
    buffer_atomic_add v250, v249, s[36:39], 0 offen sc1
    s_mov_b64 exec, -1
    v_mfma_f32_16x16x32_bf16 v[92:95], a[180:183], a[196:199], v[92:95]
    v_cndmask_b32_e64 v143, v240, -v241, vcc
    v_add_f32 v239, 0xc1800000, v239
    v_mfma_f32_16x16x32_bf16 v[96:99], a[184:187], a[200:203], v[96:99]
    v_mfma_f32_16x16x32_bf16 v[100:103], a[188:191], a[200:203], v[100:103]
    s_waitcnt lgkmcnt(0)
    s_waitcnt vmcnt(11)
    s_barrier
    v_mfma_f32_16x16x32_bf16 v[32:35], a[204:207], a[244:247], v[32:35]
    ds_read_b128 a[192:195], v15 offset:0
    v_mul_f32 v228, v239, v236
    v_mfma_f32_16x16x32_bf16 v[64:67], a[204:207], a[248:251], v[64:67]
    ds_read_b128 a[152:155], v13 offset:0
    v_mul_f32 v229, v239, v237
    v_mfma_f32_16x16x32_bf16 v[36:39], a[208:211], a[244:247], v[36:39]
    ds_read_b128 a[196:199], v15 offset:2048
    s_add_u32 m0, s58, 32768
    s_add_u32 s54, s98, 256
    buffer_load_dwordx4 v4, s[4:7], s54 offen lds
    v_mfma_f32_16x16x32_bf16 v[68:71], a[208:211], a[248:251], v[68:71]
    ds_read_b128 a[156:159], v13 offset:2048
    v_exp_f32 v228, v228
    v_mfma_f32_16x16x32_bf16 v[40:43], a[212:215], a[244:247], v[40:43]
    ds_read_b128 a[160:163], v13 offset:4096
    v_fract_f32 v229, v229
    v_mfma_f32_16x16x32_bf16 v[72:75], a[212:215], a[248:251], v[72:75]
    ds_read_b128 a[164:167], v13 offset:6144
    buffer_load_dwordx4 v5, s[4:7], s54 offen offset:1024 lds
    v_mfma_f32_16x16x32_bf16 v[44:47], a[216:219], a[244:247], v[44:47]
    ds_read_b128 a[168:171], v13 offset:8192
    v_cos_f32 v230, v229
    v_mfma_f32_16x16x32_bf16 v[76:79], a[216:219], a[248:251], v[76:79]
    ds_read_b128 a[172:175], v13 offset:10240
    v_sin_f32 v229, v229
    v_mfma_f32_16x16x32_bf16 v[48:51], a[220:223], a[244:247], v[48:51]
    ds_read_b128 a[176:179], v13 offset:12288
    buffer_load_dwordx4 v6, s[4:7], s54 offen offset:2048 lds
    v_mfma_f32_16x16x32_bf16 v[80:83], a[220:223], a[248:251], v[80:83]
    ds_read_b128 a[180:183], v13 offset:14336
    v_mul_f32 v240, v228, v230
    v_mfma_f32_16x16x32_bf16 v[52:55], a[224:227], a[244:247], v[52:55]
    ds_read_b128 a[200:203], v17 offset:0
    v_mul_f32 v241, v228, v229
    v_mfma_f32_16x16x32_bf16 v[84:87], a[224:227], a[248:251], v[84:87]
    ds_read_b128 a[184:187], v19 offset:0
    buffer_load_dwordx4 v7, s[4:7], s54 offen offset:3072 lds
    v_mfma_f32_16x16x32_bf16 v[56:59], a[228:231], a[244:247], v[56:59]
    ds_read_b128 a[188:191], v19 offset:2048
    v_cndmask_b32 v140, v241, v240, vcc
    v_mfma_f32_16x16x32_bf16 v[88:91], a[228:231], a[248:251], v[88:91]
    v_cndmask_b32_e64 v142, v240, -v241, vcc
    v_lshrrev_b32 v228, 1, v3
    v_mfma_f32_16x16x32_bf16 v[60:63], a[232:235], a[244:247], v[60:63]
    s_add_u32 m0, s59, 32768
    s_nop 0
    buffer_load_dwordx4 v8, s[8:11], s54 offen lds
    v_mfma_f32_16x16x32_bf16 v[92:95], a[232:235], a[248:251], v[92:95]
    v_lshlrev_b32 v229, 2, v2
    v_sub_u32 v228, v228, v229
    v_mfma_f32_16x16x32_bf16 v[96:99], a[236:239], a[252:255], v[96:99]
    v_mfma_f32_16x16x32_bf16 v[100:103], a[240:243], a[252:255], v[100:103]
    s_waitcnt lgkmcnt(0)
    v_mfma_f32_16x16x32_bf16 v[32:35], a[152:155], a[192:195], v[32:35]
    ds_read_b128 a[244:247], v16 offset:0
    v_and_b32 v229, 1, v3
    v_mfma_f32_16x16x32_bf16 v[64:67], a[152:155], a[196:199], v[64:67]
    ds_read_b128 a[204:207], v14 offset:0
    v_lshlrev_b32 v229, 4, v229
    v_mfma_f32_16x16x32_bf16 v[36:39], a[156:159], a[192:195], v[36:39]
    ds_read_b128 a[248:251], v16 offset:2048
    buffer_load_dwordx4 v9, s[8:11], s54 offen offset:1024 lds
    v_mfma_f32_16x16x32_bf16 v[68:71], a[156:159], a[196:199], v[68:71]
    ds_read_b128 a[208:211], v14 offset:2048
    v_lshlrev_b32 v156, v229, v156
    v_mfma_f32_16x16x32_bf16 v[40:43], a[160:163], a[192:195], v[40:43]
    ds_read_b128 a[212:215], v14 offset:4096
    v_lshlrev_b32 v157, v229, v157
    v_mfma_f32_16x16x32_bf16 v[72:75], a[160:163], a[196:199], v[72:75]
    ds_read_b128 a[216:219], v14 offset:6144
    s_add_u32 m0, s59, 34816
    s_nop 0
    buffer_load_dwordx4 v8, s[12:15], s54 offen lds
    v_mfma_f32_16x16x32_bf16 v[44:47], a[164:167], a[192:195], v[44:47]
    ds_read_b128 a[220:223], v14 offset:8192
    v_lshlrev_b32 v158, v229, v158
    v_mfma_f32_16x16x32_bf16 v[76:79], a[164:167], a[196:199], v[76:79]
    ds_read_b128 a[224:227], v14 offset:10240
    v_cmp_eq_u32 vcc, 0, v228
    v_mfma_f32_16x16x32_bf16 v[48:51], a[168:171], a[192:195], v[48:51]
    ds_read_b128 a[228:231], v14 offset:12288
    buffer_load_dwordx4 v9, s[12:15], s54 offen offset:1024 lds
    v_mfma_f32_16x16x32_bf16 v[80:83], a[168:171], a[196:199], v[80:83]
    ds_read_b128 a[232:235], v14 offset:14336
    v_cmp_eq_u32 s[56:57], -8, v228
    v_mfma_f32_16x16x32_bf16 v[52:55], a[172:175], a[192:195], v[52:55]
    ds_read_b128 a[252:255], v18 offset:0
    v_nop
    v_mfma_f32_16x16x32_bf16 v[84:87], a[172:175], a[196:199], v[84:87]
    ds_read_b128 a[236:239], v20 offset:0
    s_add_u32 m0, s60, 4096
    s_mov_b32 exec_hi, 0
    buffer_load_dwordx4 v10, s[16:19], s54 offen lds
    s_mov_b32 exec_hi, -1
    v_mfma_f32_16x16x32_bf16 v[56:59], a[176:179], a[192:195], v[56:59]
    ds_read_b128 a[240:243], v20 offset:2048
    v_cndmask_b32 v196, 0, v156, vcc
    v_mfma_f32_16x16x32_bf16 v[88:91], a[176:179], a[196:199], v[88:91]
    v_cndmask_b32 v204, 0, v158, vcc
    v_cndmask_b32_e64 v200, 0, v157, s[56:57]
    v_mfma_f32_16x16x32_bf16 v[60:63], a[180:183], a[192:195], v[60:63]
    v_cmp_eq_u32 vcc, 1, v228
    v_cmp_eq_u32 s[56:57], -7, v228
    v_mfma_f32_16x16x32_bf16 v[92:95], a[180:183], a[196:199], v[92:95]
    v_mfma_f32_16x16x32_bf16 v[96:99], a[184:187], a[200:203], v[96:99]
    v_mfma_f32_16x16x32_bf16 v[100:103], a[188:191], a[200:203], v[100:103]
    s_waitcnt lgkmcnt(0)
    s_waitcnt vmcnt(10)
    s_barrier
    v_mfma_f32_16x16x32_bf16 v[32:35], a[204:207], a[244:247], v[32:35]
    ds_read_b128 a[192:195], v15 offset:16384
    v_nop
    v_mfma_f32_16x16x32_bf16 v[64:67], a[204:207], a[248:251], v[64:67]
    ds_read_b128 a[152:155], v13 offset:16384
    v_cndmask_b32 v197, 0, v156, vcc
    v_mfma_f32_16x16x32_bf16 v[36:39], a[208:211], a[244:247], v[36:39]
    ds_read_b128 a[196:199], v15 offset:18432
    s_add_u32 m0, s58, 0
    s_bfe_u32 s55, s1, 524288
    s_lshl_b32 s55, s55, 7
    buffer_load_dwordx4 v252, s[20:23], s55 offen lds
    v_mfma_f32_16x16x32_bf16 v[68:71], a[208:211], a[248:251], v[68:71]
    ds_read_b128 a[156:159], v13 offset:18432
    v_cndmask_b32 v205, 0, v158, vcc
    v_mfma_f32_16x16x32_bf16 v[40:43], a[212:215], a[244:247], v[40:43]
    ds_read_b128 a[160:163], v13 offset:20480
    v_cndmask_b32_e64 v201, 0, v157, s[56:57]
    v_mfma_f32_16x16x32_bf16 v[72:75], a[212:215], a[248:251], v[72:75]
    ds_read_b128 a[164:167], v13 offset:22528
    buffer_load_dwordx4 v253, s[20:23], s55 offen offset:1024 lds
    v_mfma_f32_16x16x32_bf16 v[44:47], a[216:219], a[244:247], v[44:47]
    ds_read_b128 a[168:171], v13 offset:24576
    v_cmp_eq_u32 vcc, 2, v228
    v_mfma_f32_16x16x32_bf16 v[76:79], a[216:219], a[248:251], v[76:79]
    ds_read_b128 a[172:175], v13 offset:26624
    v_cmp_eq_u32 s[56:57], -6, v228
    v_mfma_f32_16x16x32_bf16 v[48:51], a[220:223], a[244:247], v[48:51]
    ds_read_b128 a[176:179], v13 offset:28672
    buffer_load_dwordx4 v254, s[20:23], s55 offen offset:2048 lds
    v_mfma_f32_16x16x32_bf16 v[80:83], a[220:223], a[248:251], v[80:83]
    ds_read_b128 a[180:183], v13 offset:30720
    v_nop
    v_mfma_f32_16x16x32_bf16 v[52:55], a[224:227], a[244:247], v[52:55]
    ds_read_b128 a[200:203], v17 offset:2048
    v_cndmask_b32 v198, 0, v156, vcc
    v_mfma_f32_16x16x32_bf16 v[84:87], a[224:227], a[248:251], v[84:87]
    ds_read_b128 a[184:187], v19 offset:16384
    v_cndmask_b32 v206, 0, v158, vcc
    v_mfma_f32_16x16x32_bf16 v[56:59], a[228:231], a[244:247], v[56:59]
    ds_read_b128 a[188:191], v19 offset:18432
    v_cndmask_b32_e64 v202, 0, v157, s[56:57]
    v_mfma_f32_16x16x32_bf16 v[88:91], a[228:231], a[248:251], v[88:91]
    v_cmp_eq_u32 vcc, 3, v228
    v_cmp_eq_u32 s[56:57], -5, v228
    v_mfma_f32_16x16x32_bf16 v[60:63], a[232:235], a[244:247], v[60:63]
    v_nop
    v_mfma_f32_16x16x32_bf16 v[92:95], a[232:235], a[248:251], v[92:95]
    v_mfma_f32_16x16x32_bf16 v[96:99], a[236:239], a[252:255], v[96:99]
    v_mfma_f32_16x16x32_bf16 v[100:103], a[240:243], a[252:255], v[100:103]
    s_waitcnt lgkmcnt(0)
    v_mfma_f32_16x16x32_bf16 v[32:35], a[152:155], a[192:195], v[32:35]
    ds_read_b128 a[244:247], v16 offset:16384
    v_cndmask_b32 v199, 0, v156, vcc
    v_mfma_f32_16x16x32_bf16 v[64:67], a[152:155], a[196:199], v[64:67]
    ds_read_b128 a[204:207], v14 offset:16384
    v_cndmask_b32 v207, 0, v158, vcc
    v_mfma_f32_16x16x32_bf16 v[36:39], a[156:159], a[192:195], v[36:39]
    ds_read_b128 a[248:251], v16 offset:18432
    buffer_load_dwordx4 v255, s[20:23], s55 offen offset:3072 lds
    v_mfma_f32_16x16x32_bf16 v[68:71], a[156:159], a[196:199], v[68:71]
    ds_read_b128 a[208:211], v14 offset:18432
    v_cndmask_b32_e64 v203, 0, v157, s[56:57]
    v_mfma_f32_16x16x32_bf16 v[40:43], a[160:163], a[192:195], v[40:43]
    ds_read_b128 a[212:215], v14 offset:20480
    v_lshlrev_b32 v251, 6, v3
    v_mfma_f32_16x16x32_bf16 v[72:75], a[160:163], a[196:199], v[72:75]
    ds_read_b128 a[216:219], v14 offset:22528
    s_add_u32 m0, s58, 49152
    s_bfe_u32 s55, s1, 524288
    s_lshl_b32 s55, s55, 7
    buffer_load_dwordx4 v252, s[24:27], s55 offen lds
    v_mfma_f32_16x16x32_bf16 v[44:47], a[164:167], a[192:195], v[44:47]
    ds_read_b128 a[220:223], v14 offset:24576
    v_lshl_add_u32 v251, v2, 4, v251
    v_mfma_f32_16x16x32_bf16 v[76:79], a[164:167], a[196:199], v[76:79]
    ds_read_b128 a[224:227], v14 offset:26624
    v_and_b32 v242, 11, v3
    v_mfma_f32_16x16x32_bf16 v[48:51], a[168:171], a[192:195], v[48:51]
    ds_read_b128 a[228:231], v14 offset:28672
    buffer_load_dwordx4 v253, s[24:27], s55 offen offset:1024 lds
    v_mfma_f32_16x16x32_bf16 v[80:83], a[168:171], a[196:199], v[80:83]
    ds_read_b128 a[232:235], v14 offset:30720
    v_lshlrev_b32 v242, 4, v242
    v_mfma_f32_16x16x32_bf16 v[52:55], a[172:175], a[192:195], v[52:55]
    ds_read_b128 a[252:255], v18 offset:2048
    v_lshrrev_b32 v228, 1, v2
    v_mfma_f32_16x16x32_bf16 v[84:87], a[172:175], a[196:199], v[84:87]
    ds_read_b128 a[236:239], v20 offset:16384
    v_lshl_add_u32 v242, v228, 6, v242
    v_mfma_f32_16x16x32_bf16 v[56:59], a[176:179], a[192:195], v[56:59]
    ds_read_b128 a[240:243], v20 offset:18432
    v_bfe_u32 v228, v3, 2, 1
    v_mfma_f32_16x16x32_bf16 v[88:91], a[176:179], a[196:199], v[88:91]
    v_lshl_add_u32 v242, v228, 8, v242
    v_and_b32 v228, 1, v2
    v_mfma_f32_16x16x32_bf16 v[60:63], a[180:183], a[192:195], v[60:63]
    v_lshl_add_u32 v242, v228, 9, v242
    v_mfma_f32_16x16x32_bf16 v[92:95], a[180:183], a[196:199], v[92:95]
    v_mfma_f32_16x16x32_bf16 v[96:99], a[184:187], a[200:203], v[96:99]
    v_mfma_f32_16x16x32_bf16 v[100:103], a[188:191], a[200:203], v[100:103]
    s_waitcnt lgkmcnt(0)
    s_waitcnt vmcnt(6)
    s_barrier
    v_mfma_f32_16x16x32_bf16 v[32:35], a[204:207], a[244:247], v[32:35]
    ds_read_b128 a[192:195], v15 offset:32768
    s_lshl_b32 s56, s51, 11
    v_mfma_f32_16x16x32_bf16 v[64:67], a[204:207], a[248:251], v[64:67]
    ds_read_b128 a[152:155], v13 offset:32768
    v_add_u32 v242, s56, v242
    v_mfma_f32_16x16x32_bf16 v[36:39], a[208:211], a[244:247], v[36:39]
    ds_read_b128 a[196:199], v15 offset:34816
    buffer_load_dwordx4 v254, s[24:27], s55 offen offset:2048 lds
    v_mfma_f32_16x16x32_bf16 v[68:71], a[208:211], a[248:251], v[68:71]
    ds_read_b128 a[156:159], v13 offset:34816
    v_add_u32 v244, s61, v251
    v_mfma_f32_16x16x32_bf16 v[40:43], a[212:215], a[244:247], v[40:43]
    ds_read_b128 a[160:163], v13 offset:36864
    v_add_u32 v251, s58, v251
    v_mfma_f32_16x16x32_bf16 v[72:75], a[212:215], a[248:251], v[72:75]
    ds_read_b128 a[164:167], v13 offset:38912
    buffer_load_dwordx4 v255, s[24:27], s55 offen offset:3072 lds
    v_mfma_f32_16x16x32_bf16 v[44:47], a[216:219], a[244:247], v[44:47]
    ds_read_b128 a[168:171], v13 offset:40960
    v_add_u32 v251, 98304, v251
    v_mfma_f32_16x16x32_bf16 v[76:79], a[216:219], a[248:251], v[76:79]
    ds_read_b128 a[172:175], v13 offset:43008
    v_mfma_f32_16x16x32_bf16 v[48:51], a[220:223], a[244:247], v[48:51]
    ds_read_b128 a[176:179], v13 offset:45056
    v_mfma_f32_16x16x32_bf16 v[80:83], a[220:223], a[248:251], v[80:83]
    ds_read_b128 a[180:183], v13 offset:47104
    v_mfma_f32_16x16x32_bf16 v[52:55], a[224:227], a[244:247], v[52:55]
    ds_read_b128 a[200:203], v17 offset:4096
    v_mfma_f32_16x16x32_bf16 v[84:87], a[224:227], a[248:251], v[84:87]
    ds_read_b128 a[184:187], v19 offset:32768
    v_mfma_f32_16x16x32_bf16 v[56:59], a[228:231], a[244:247], v[56:59]
    ds_read_b128 a[188:191], v19 offset:34816
    v_mfma_f32_16x16x32_bf16 v[88:91], a[228:231], a[248:251], v[88:91]
    v_mfma_f32_16x16x32_bf16 v[60:63], a[232:235], a[244:247], v[60:63]
    v_mfma_f32_16x16x32_bf16 v[92:95], a[232:235], a[248:251], v[92:95]
    v_mfma_f32_16x16x32_bf16 v[96:99], a[236:239], a[252:255], v[96:99]
    v_mfma_f32_16x16x32_bf16 v[100:103], a[240:243], a[252:255], v[100:103]
    s_waitcnt lgkmcnt(0)
    v_mfma_f32_16x16x32_bf16 v[32:35], a[152:155], a[192:195], v[32:35]
    ds_read_b128 a[244:247], v16 offset:32768
    v_mfma_f32_16x16x32_bf16 v[64:67], a[152:155], a[196:199], v[64:67]
    ds_read_b128 a[204:207], v14 offset:32768
    v_mfma_f32_16x16x32_bf16 v[36:39], a[156:159], a[192:195], v[36:39]
    ds_read_b128 a[248:251], v16 offset:34816
    v_mfma_f32_16x16x32_bf16 v[68:71], a[156:159], a[196:199], v[68:71]
    ds_read_b128 a[208:211], v14 offset:34816
    v_mfma_f32_16x16x32_bf16 v[40:43], a[160:163], a[192:195], v[40:43]
    ds_read_b128 a[212:215], v14 offset:36864
    v_mfma_f32_16x16x32_bf16 v[72:75], a[160:163], a[196:199], v[72:75]
    ds_read_b128 a[216:219], v14 offset:38912
    v_mfma_f32_16x16x32_bf16 v[44:47], a[164:167], a[192:195], v[44:47]
    ds_read_b128 a[220:223], v14 offset:40960
    v_mfma_f32_16x16x32_bf16 v[76:79], a[164:167], a[196:199], v[76:79]
    ds_read_b128 a[224:227], v14 offset:43008
    v_mfma_f32_16x16x32_bf16 v[48:51], a[168:171], a[192:195], v[48:51]
    ds_read_b128 a[228:231], v14 offset:45056
    v_mfma_f32_16x16x32_bf16 v[80:83], a[168:171], a[196:199], v[80:83]
    ds_read_b128 a[232:235], v14 offset:47104
    v_mfma_f32_16x16x32_bf16 v[52:55], a[172:175], a[192:195], v[52:55]
    ds_read_b128 a[252:255], v18 offset:4096
    v_mfma_f32_16x16x32_bf16 v[84:87], a[172:175], a[196:199], v[84:87]
    ds_read_b128 a[236:239], v20 offset:32768
    v_mfma_f32_16x16x32_bf16 v[56:59], a[176:179], a[192:195], v[56:59]
    ds_read_b128 a[240:243], v20 offset:34816
    v_mfma_f32_16x16x32_bf16 v[88:91], a[176:179], a[196:199], v[88:91]
    v_mfma_f32_16x16x32_bf16 v[60:63], a[180:183], a[192:195], v[60:63]
    v_mfma_f32_16x16x32_bf16 v[92:95], a[180:183], a[196:199], v[92:95]
    v_mfma_f32_16x16x32_bf16 v[96:99], a[184:187], a[200:203], v[96:99]
    v_mfma_f32_16x16x32_bf16 v[100:103], a[188:191], a[200:203], v[100:103]
    s_waitcnt lgkmcnt(0)
    v_mfma_f32_16x16x32_bf16 v[32:35], a[204:207], a[244:247], v[32:35]
    v_mfma_f32_16x16x32_bf16 v[64:67], a[204:207], a[248:251], v[64:67]
    v_mfma_f32_16x16x32_bf16 v[36:39], a[208:211], a[244:247], v[36:39]
    s_add_u32 m0, s62, 4096
    s_bfe_u32 s55, s1, 524288
    s_lshl_b32 s55, s55, 7
    buffer_load_dwordx4 v11, s[44:47], s55 offen lds
    v_mfma_f32_16x16x32_bf16 v[68:71], a[208:211], a[248:251], v[68:71]
    v_mfma_f32_16x16x32_bf16 v[40:43], a[212:215], a[244:247], v[40:43]
    v_mfma_f32_16x16x32_bf16 v[72:75], a[212:215], a[248:251], v[72:75]
    s_mov_b64 exec, 0x1ff
    buffer_load_dword v243, v245, s[44:47], 0 offen
    s_mov_b64 exec, -1
    v_mfma_f32_16x16x32_bf16 v[44:47], a[216:219], a[244:247], v[44:47]
    v_mfma_f32_16x16x32_bf16 v[76:79], a[216:219], a[248:251], v[76:79]
    v_mfma_f32_16x16x32_bf16 v[48:51], a[220:223], a[244:247], v[48:51]
    buffer_load_dword v194, v155, s[36:39], 0 offen sc1
    v_mfma_f32_16x16x32_bf16 v[80:83], a[220:223], a[248:251], v[80:83]
    v_mfma_f32_16x16x32_bf16 v[52:55], a[224:227], a[244:247], v[52:55]
    v_mfma_f32_16x16x32_bf16 v[84:87], a[224:227], a[248:251], v[84:87]
    v_mfma_f32_16x16x32_bf16 v[56:59], a[228:231], a[244:247], v[56:59]
    v_mfma_f32_16x16x32_bf16 v[88:91], a[228:231], a[248:251], v[88:91]
    v_mfma_f32_16x16x32_bf16 v[60:63], a[232:235], a[244:247], v[60:63]
    v_mfma_f32_16x16x32_bf16 v[92:95], a[232:235], a[248:251], v[92:95]
    v_mfma_f32_16x16x32_bf16 v[96:99], a[236:239], a[252:255], v[96:99]
    v_mfma_f32_16x16x32_bf16 v[100:103], a[240:243], a[252:255], v[100:103]
.p2align 3
    v_pk_fma_f32 v[160:161], v[104:105], v[32:33], v[34:35] op_sel:[0,0,0] op_sel_hi:[0,1,1]
    v_pk_fma_f32 v[162:163], v[104:105], v[64:65], v[66:67] op_sel:[0,0,0] op_sel_hi:[0,1,1]
    v_pk_fma_f32 v[162:163], v[104:105], v[32:33], v[162:163] op_sel:[1,0,0] op_sel_hi:[1,1,1]
    v_pk_fma_f32 v[160:161], v[104:105], v[64:65], v[160:161] op_sel:[1,0,0] op_sel_hi:[1,1,1] neg_lo:[1,0,0] neg_hi:[1,0,0]
    v_pk_fma_f32 v[164:165], v[104:105], v[160:161], v[36:37] op_sel:[0,0,0] op_sel_hi:[0,1,1]
    v_pk_fma_f32 v[166:167], v[104:105], v[162:163], v[68:69] op_sel:[0,0,0] op_sel_hi:[0,1,1]
    v_pk_fma_f32 v[166:167], v[104:105], v[160:161], v[166:167] op_sel:[1,0,0] op_sel_hi:[1,1,1]
    v_pk_fma_f32 v[164:165], v[104:105], v[162:163], v[164:165] op_sel:[1,0,0] op_sel_hi:[1,1,1] neg_lo:[1,0,0] neg_hi:[1,0,0]
    v_pk_fma_f32 v[160:161], v[104:105], v[164:165], v[38:39] op_sel:[0,0,0] op_sel_hi:[0,1,1]
    v_pk_fma_f32 v[168:169], v[128:129], v[96:97], v[98:99] op_sel:[0,0,0] op_sel_hi:[0,1,1]
    v_pk_fma_f32 v[162:163], v[104:105], v[166:167], v[70:71] op_sel:[0,0,0] op_sel_hi:[0,1,1]
    v_pk_fma_f32 v[162:163], v[104:105], v[164:165], v[162:163] op_sel:[1,0,0] op_sel_hi:[1,1,1]
    v_pk_fma_f32 v[160:161], v[104:105], v[166:167], v[160:161] op_sel:[1,0,0] op_sel_hi:[1,1,1] neg_lo:[1,0,0] neg_hi:[1,0,0]
    v_fmac_f32_dpp v168, v96, v129 row_ror:8 row_mask:0xf bank_mask:0xf
    v_pk_fma_f32 v[164:165], v[104:105], v[160:161], v[40:41] op_sel:[0,0,0] op_sel_hi:[0,1,1]
    v_pk_fma_f32 v[166:167], v[104:105], v[162:163], v[72:73] op_sel:[0,0,0] op_sel_hi:[0,1,1]
    v_pk_fma_f32 v[166:167], v[104:105], v[160:161], v[166:167] op_sel:[1,0,0] op_sel_hi:[1,1,1]
    v_fmac_f32_dpp v169, v97, v129 row_ror:8 row_mask:0xf bank_mask:0xf
    v_pk_fma_f32 v[164:165], v[104:105], v[162:163], v[164:165] op_sel:[1,0,0] op_sel_hi:[1,1,1] neg_lo:[1,0,0] neg_hi:[1,0,0]
    v_pk_fma_f32 v[160:161], v[104:105], v[164:165], v[42:43] op_sel:[0,0,0] op_sel_hi:[0,1,1]
    v_pk_fma_f32 v[162:163], v[104:105], v[166:167], v[74:75] op_sel:[0,0,0] op_sel_hi:[0,1,1]
    v_pk_fma_f32 v[170:171], v[128:129], v[168:169], v[100:101] op_sel:[0,0,0] op_sel_hi:[0,1,1]
    v_pk_fma_f32 v[162:163], v[104:105], v[164:165], v[162:163] op_sel:[1,0,0] op_sel_hi:[1,1,1]
    v_pk_fma_f32 v[160:161], v[104:105], v[166:167], v[160:161] op_sel:[1,0,0] op_sel_hi:[1,1,1] neg_lo:[1,0,0] neg_hi:[1,0,0]
    v_pk_fma_f32 v[164:165], v[104:105], v[160:161], v[44:45] op_sel:[0,0,0] op_sel_hi:[0,1,1]
    v_fmac_f32_dpp v170, v168, v129 row_ror:8 row_mask:0xf bank_mask:0xf
    v_pk_fma_f32 v[166:167], v[104:105], v[162:163], v[76:77] op_sel:[0,0,0] op_sel_hi:[0,1,1]
    v_pk_fma_f32 v[166:167], v[104:105], v[160:161], v[166:167] op_sel:[1,0,0] op_sel_hi:[1,1,1]
    v_pk_fma_f32 v[164:165], v[104:105], v[162:163], v[164:165] op_sel:[1,0,0] op_sel_hi:[1,1,1] neg_lo:[1,0,0] neg_hi:[1,0,0]
    v_fmac_f32_dpp v171, v169, v129 row_ror:8 row_mask:0xf bank_mask:0xf
    v_pk_fma_f32 v[160:161], v[104:105], v[164:165], v[46:47] op_sel:[0,0,0] op_sel_hi:[0,1,1]
    v_pk_fma_f32 v[162:163], v[104:105], v[166:167], v[78:79] op_sel:[0,0,0] op_sel_hi:[0,1,1]
    v_pk_fma_f32 v[162:163], v[104:105], v[164:165], v[162:163] op_sel:[1,0,0] op_sel_hi:[1,1,1]
    v_pk_fma_f32 v[168:169], v[128:129], v[170:171], v[102:103] op_sel:[0,0,0] op_sel_hi:[0,1,1]
    v_pk_fma_f32 v[160:161], v[104:105], v[166:167], v[160:161] op_sel:[1,0,0] op_sel_hi:[1,1,1] neg_lo:[1,0,0] neg_hi:[1,0,0]
    v_pk_fma_f32 v[164:165], v[104:105], v[160:161], v[48:49] op_sel:[0,0,0] op_sel_hi:[0,1,1]
    v_pk_fma_f32 v[166:167], v[104:105], v[162:163], v[80:81] op_sel:[0,0,0] op_sel_hi:[0,1,1]
    v_fmac_f32_dpp v168, v170, v129 row_ror:8 row_mask:0xf bank_mask:0xf
    v_pk_fma_f32 v[166:167], v[104:105], v[160:161], v[166:167] op_sel:[1,0,0] op_sel_hi:[1,1,1]
    v_pk_fma_f32 v[164:165], v[104:105], v[162:163], v[164:165] op_sel:[1,0,0] op_sel_hi:[1,1,1] neg_lo:[1,0,0] neg_hi:[1,0,0]
    v_pk_fma_f32 v[160:161], v[104:105], v[164:165], v[50:51] op_sel:[0,0,0] op_sel_hi:[0,1,1]
    v_fmac_f32_dpp v169, v171, v129 row_ror:8 row_mask:0xf bank_mask:0xf
    v_pk_fma_f32 v[162:163], v[104:105], v[166:167], v[82:83] op_sel:[0,0,0] op_sel_hi:[0,1,1]
    v_pk_fma_f32 v[162:163], v[104:105], v[164:165], v[162:163] op_sel:[1,0,0] op_sel_hi:[1,1,1]
    v_pk_fma_f32 v[160:161], v[104:105], v[166:167], v[160:161] op_sel:[1,0,0] op_sel_hi:[1,1,1] neg_lo:[1,0,0] neg_hi:[1,0,0]
    v_mul_f32_e64 v172, v132, v168
    v_pk_fma_f32 v[164:165], v[104:105], v[160:161], v[52:53] op_sel:[0,0,0] op_sel_hi:[0,1,1]
    v_pk_fma_f32 v[166:167], v[104:105], v[162:163], v[84:85] op_sel:[0,0,0] op_sel_hi:[0,1,1]
    v_pk_fma_f32 v[166:167], v[104:105], v[160:161], v[166:167] op_sel:[1,0,0] op_sel_hi:[1,1,1]
    v_fmac_f32_dpp v172, v168, v134 row_ror:8 row_mask:0xf bank_mask:0xf
    v_pk_fma_f32 v[164:165], v[104:105], v[162:163], v[164:165] op_sel:[1,0,0] op_sel_hi:[1,1,1] neg_lo:[1,0,0] neg_hi:[1,0,0]
    v_pk_fma_f32 v[160:161], v[104:105], v[164:165], v[54:55] op_sel:[0,0,0] op_sel_hi:[0,1,1]
    v_pk_fma_f32 v[162:163], v[104:105], v[166:167], v[86:87] op_sel:[0,0,0] op_sel_hi:[0,1,1]
    v_fmac_f32_e64 v172, v133, v169
    v_pk_fma_f32 v[162:163], v[104:105], v[164:165], v[162:163] op_sel:[1,0,0] op_sel_hi:[1,1,1]
    v_pk_fma_f32 v[160:161], v[104:105], v[166:167], v[160:161] op_sel:[1,0,0] op_sel_hi:[1,1,1] neg_lo:[1,0,0] neg_hi:[1,0,0]
    v_pk_fma_f32 v[164:165], v[104:105], v[160:161], v[56:57] op_sel:[0,0,0] op_sel_hi:[0,1,1]
    v_fmac_f32_dpp v172, v169, v135 row_ror:8 row_mask:0xf bank_mask:0xf
    v_pk_fma_f32 v[166:167], v[104:105], v[162:163], v[88:89] op_sel:[0,0,0] op_sel_hi:[0,1,1]
    v_pk_fma_f32 v[166:167], v[104:105], v[160:161], v[166:167] op_sel:[1,0,0] op_sel_hi:[1,1,1]
    v_pk_fma_f32 v[164:165], v[104:105], v[162:163], v[164:165] op_sel:[1,0,0] op_sel_hi:[1,1,1] neg_lo:[1,0,0] neg_hi:[1,0,0]
    v_mov_b32_e64 v173, v172
    v_pk_fma_f32 v[160:161], v[104:105], v[164:165], v[58:59] op_sel:[0,0,0] op_sel_hi:[0,1,1]
    v_pk_fma_f32 v[162:163], v[104:105], v[166:167], v[90:91] op_sel:[0,0,0] op_sel_hi:[0,1,1]
    v_pk_fma_f32 v[162:163], v[104:105], v[164:165], v[162:163] op_sel:[1,0,0] op_sel_hi:[1,1,1]
    v_permlane16_swap_b32 v172, v173
    v_add_f32 v172, v172, v173
    v_pk_fma_f32 v[160:161], v[104:105], v[166:167], v[160:161] op_sel:[1,0,0] op_sel_hi:[1,1,1] neg_lo:[1,0,0] neg_hi:[1,0,0]
    v_pk_fma_f32 v[164:165], v[104:105], v[160:161], v[60:61] op_sel:[0,0,0] op_sel_hi:[0,1,1]
    v_pk_fma_f32 v[166:167], v[104:105], v[162:163], v[92:93] op_sel:[0,0,0] op_sel_hi:[0,1,1]
    v_pk_fma_f32 v[166:167], v[104:105], v[160:161], v[166:167] op_sel:[1,0,0] op_sel_hi:[1,1,1]
    v_pk_fma_f32 v[164:165], v[104:105], v[162:163], v[164:165] op_sel:[1,0,0] op_sel_hi:[1,1,1] neg_lo:[1,0,0] neg_hi:[1,0,0]
    v_pk_fma_f32 v[160:161], v[104:105], v[164:165], v[62:63] op_sel:[0,0,0] op_sel_hi:[0,1,1]
    v_pk_fma_f32 v[162:163], v[104:105], v[166:167], v[94:95] op_sel:[0,0,0] op_sel_hi:[0,1,1]
    v_pk_fma_f32 v[162:163], v[104:105], v[164:165], v[162:163] op_sel:[1,0,0] op_sel_hi:[1,1,1]
    v_pk_fma_f32 v[160:161], v[104:105], v[166:167], v[160:161] op_sel:[1,0,0] op_sel_hi:[1,1,1] neg_lo:[1,0,0] neg_hi:[1,0,0]
    v_pk_mul_f32 v[164:165], v[108:109], v[160:161] op_sel:[0,0] op_sel_hi:[1,1]
    v_pk_mul_f32 v[166:167], v[108:109], v[162:163] op_sel:[0,0] op_sel_hi:[1,1]
    v_pk_fma_f32 v[164:165], v[110:111], v[162:163], v[164:165] op_sel:[0,0,0] op_sel_hi:[1,1,1] neg_lo:[1,0,0] neg_hi:[1,0,0]
    v_pk_fma_f32 v[166:167], v[110:111], v[160:161], v[166:167] op_sel:[0,0,0] op_sel_hi:[1,1,1]
    v_add_f32 v164, v164, v165
    v_add_f32 v166, v166, v167
    s_mov_b32 exec_hi, -1
    s_nop 0
    v_permlane16_swap_b32 v164, v166
    v_add_f32 v164, v164, v166
    s_nop 1
    v_permlane32_swap_b32 v164, v172
    v_add_f32 v164, v164, v172
    v_min_u32 v164, -2, v164
    s_mov_b32 exec_hi, 0xffff
    buffer_store_dword v164, v21, s[28:31], 0 offen sc1
    s_mov_b32 exec_hi, -1
    v_pk_mul_f32 v[174:175], v[130:131], v[168:169] op_sel:[0,0] op_sel_hi:[0,1]
    v_lshlrev_b32 v176, 3, v0
    s_nop 0
    v_fmac_f32_dpp v174, v168, v131 row_ror:8 row_mask:0xf bank_mask:0xf
    v_fmac_f32_dpp v175, v169, v131 row_ror:8 row_mask:0xf bank_mask:0xf
    v_add_u32 v176, 124928, v176
    ds_write_b64 v176, v[174:175]
    s_waitcnt lgkmcnt(0)
    s_barrier
    v_lshlrev_b32 v184, 3, v1
    v_add_u32 v184, 124928, v184
    ds_read_b64 v[176:177], v184
    ds_read_b64 v[178:179], v184 offset:512
    ds_read_b64 v[180:181], v184 offset:1024
    ds_read_b64 v[182:183], v184 offset:1536
    v_pk_mul_f32 v[186:187], v[106:107], v[64:65] op_sel:[1,0] op_sel_hi:[1,1]
    s_add_u32 m0, s58, 98304
    s_nop 0
    buffer_load_dwordx4 v246, s[4:7], s72 offen lds
    v_pk_mul_f32 v[64:65], v[106:107], v[64:65] op_sel:[0,0] op_sel_hi:[0,1]
    v_pk_fma_f32 v[64:65], v[106:107], v[32:33], v[64:65] op_sel:[1,0,0] op_sel_hi:[1,1,1]
    v_pk_fma_f32 v[32:33], v[106:107], v[32:33], v[186:187] op_sel:[0,0,0] op_sel_hi:[0,1,1] neg_lo:[0,0,1] neg_hi:[0,0,1]
    v_pk_mul_f32 v[188:189], v[106:107], v[66:67] op_sel:[1,0] op_sel_hi:[1,1]
    v_pk_mul_f32 v[66:67], v[106:107], v[66:67] op_sel:[0,0] op_sel_hi:[0,1]
    v_pk_fma_f32 v[66:67], v[106:107], v[34:35], v[66:67] op_sel:[1,0,0] op_sel_hi:[1,1,1]
    v_pk_fma_f32 v[34:35], v[106:107], v[34:35], v[188:189] op_sel:[0,0,0] op_sel_hi:[0,1,1] neg_lo:[0,0,1] neg_hi:[0,0,1]
    v_pk_mul_f32 v[186:187], v[106:107], v[68:69] op_sel:[1,0] op_sel_hi:[1,1]
    v_pk_mul_f32 v[68:69], v[106:107], v[68:69] op_sel:[0,0] op_sel_hi:[0,1]
    v_pk_fma_f32 v[68:69], v[106:107], v[36:37], v[68:69] op_sel:[1,0,0] op_sel_hi:[1,1,1]
    v_pk_fma_f32 v[36:37], v[106:107], v[36:37], v[186:187] op_sel:[0,0,0] op_sel_hi:[0,1,1] neg_lo:[0,0,1] neg_hi:[0,0,1]
    s_add_u32 m0, s58, 99328
    s_nop 0
    buffer_load_dwordx4 v247, s[4:7], s72 offen lds
    v_pk_mul_f32 v[188:189], v[106:107], v[70:71] op_sel:[1,0] op_sel_hi:[1,1]
    v_pk_mul_f32 v[70:71], v[106:107], v[70:71] op_sel:[0,0] op_sel_hi:[0,1]
    v_pk_fma_f32 v[70:71], v[106:107], v[38:39], v[70:71] op_sel:[1,0,0] op_sel_hi:[1,1,1]
    v_pk_fma_f32 v[38:39], v[106:107], v[38:39], v[188:189] op_sel:[0,0,0] op_sel_hi:[0,1,1] neg_lo:[0,0,1] neg_hi:[0,0,1]
    v_pk_mul_f32 v[186:187], v[106:107], v[72:73] op_sel:[1,0] op_sel_hi:[1,1]
    v_pk_mul_f32 v[72:73], v[106:107], v[72:73] op_sel:[0,0] op_sel_hi:[0,1]
    v_pk_fma_f32 v[72:73], v[106:107], v[40:41], v[72:73] op_sel:[1,0,0] op_sel_hi:[1,1,1]
    v_pk_fma_f32 v[40:41], v[106:107], v[40:41], v[186:187] op_sel:[0,0,0] op_sel_hi:[0,1,1] neg_lo:[0,0,1] neg_hi:[0,0,1]
    v_pk_mul_f32 v[188:189], v[106:107], v[74:75] op_sel:[1,0] op_sel_hi:[1,1]
    v_pk_mul_f32 v[74:75], v[106:107], v[74:75] op_sel:[0,0] op_sel_hi:[0,1]
    v_pk_fma_f32 v[74:75], v[106:107], v[42:43], v[74:75] op_sel:[1,0,0] op_sel_hi:[1,1,1]
    s_add_u32 m0, s58, 100352
    s_nop 0
    buffer_load_dwordx4 v246, s[4:7], s73 offen lds
    v_pk_fma_f32 v[42:43], v[106:107], v[42:43], v[188:189] op_sel:[0,0,0] op_sel_hi:[0,1,1] neg_lo:[0,0,1] neg_hi:[0,0,1]
    v_pk_mul_f32 v[186:187], v[106:107], v[76:77] op_sel:[1,0] op_sel_hi:[1,1]
    v_pk_mul_f32 v[76:77], v[106:107], v[76:77] op_sel:[0,0] op_sel_hi:[0,1]
    v_pk_fma_f32 v[76:77], v[106:107], v[44:45], v[76:77] op_sel:[1,0,0] op_sel_hi:[1,1,1]
    v_pk_fma_f32 v[44:45], v[106:107], v[44:45], v[186:187] op_sel:[0,0,0] op_sel_hi:[0,1,1] neg_lo:[0,0,1] neg_hi:[0,0,1]
    v_pk_mul_f32 v[188:189], v[106:107], v[78:79] op_sel:[1,0] op_sel_hi:[1,1]
    v_pk_mul_f32 v[78:79], v[106:107], v[78:79] op_sel:[0,0] op_sel_hi:[0,1]
    v_pk_fma_f32 v[78:79], v[106:107], v[46:47], v[78:79] op_sel:[1,0,0] op_sel_hi:[1,1,1]
    v_pk_fma_f32 v[46:47], v[106:107], v[46:47], v[188:189] op_sel:[0,0,0] op_sel_hi:[0,1,1] neg_lo:[0,0,1] neg_hi:[0,0,1]
    v_pk_mul_f32 v[186:187], v[106:107], v[80:81] op_sel:[1,0] op_sel_hi:[1,1]
    v_pk_mul_f32 v[80:81], v[106:107], v[80:81] op_sel:[0,0] op_sel_hi:[0,1]
    s_add_u32 m0, s58, 101376
    s_nop 0
    buffer_load_dwordx4 v247, s[4:7], s73 offen lds
    v_pk_fma_f32 v[80:81], v[106:107], v[48:49], v[80:81] op_sel:[1,0,0] op_sel_hi:[1,1,1]
    v_pk_fma_f32 v[48:49], v[106:107], v[48:49], v[186:187] op_sel:[0,0,0] op_sel_hi:[0,1,1] neg_lo:[0,0,1] neg_hi:[0,0,1]
    v_pk_mul_f32 v[188:189], v[106:107], v[82:83] op_sel:[1,0] op_sel_hi:[1,1]
    v_pk_mul_f32 v[82:83], v[106:107], v[82:83] op_sel:[0,0] op_sel_hi:[0,1]
    v_pk_fma_f32 v[82:83], v[106:107], v[50:51], v[82:83] op_sel:[1,0,0] op_sel_hi:[1,1,1]
    v_pk_fma_f32 v[50:51], v[106:107], v[50:51], v[188:189] op_sel:[0,0,0] op_sel_hi:[0,1,1] neg_lo:[0,0,1] neg_hi:[0,0,1]
    v_pk_mul_f32 v[186:187], v[106:107], v[84:85] op_sel:[1,0] op_sel_hi:[1,1]
    v_pk_mul_f32 v[84:85], v[106:107], v[84:85] op_sel:[0,0] op_sel_hi:[0,1]
    v_pk_fma_f32 v[84:85], v[106:107], v[52:53], v[84:85] op_sel:[1,0,0] op_sel_hi:[1,1,1]
    v_pk_fma_f32 v[52:53], v[106:107], v[52:53], v[186:187] op_sel:[0,0,0] op_sel_hi:[0,1,1] neg_lo:[0,0,1] neg_hi:[0,0,1]
    v_pk_mul_f32 v[188:189], v[106:107], v[86:87] op_sel:[1,0] op_sel_hi:[1,1]
    s_mov_b32 m0, s61
    s_nop 0
    buffer_load_dwordx4 v248, s[4:7], s72 offen lds
    v_pk_mul_f32 v[86:87], v[106:107], v[86:87] op_sel:[0,0] op_sel_hi:[0,1]
    v_pk_fma_f32 v[86:87], v[106:107], v[54:55], v[86:87] op_sel:[1,0,0] op_sel_hi:[1,1,1]
    v_pk_fma_f32 v[54:55], v[106:107], v[54:55], v[188:189] op_sel:[0,0,0] op_sel_hi:[0,1,1] neg_lo:[0,0,1] neg_hi:[0,0,1]
    v_pk_mul_f32 v[186:187], v[106:107], v[88:89] op_sel:[1,0] op_sel_hi:[1,1]
    v_pk_mul_f32 v[88:89], v[106:107], v[88:89] op_sel:[0,0] op_sel_hi:[0,1]
    v_pk_fma_f32 v[88:89], v[106:107], v[56:57], v[88:89] op_sel:[1,0,0] op_sel_hi:[1,1,1]
    v_pk_fma_f32 v[56:57], v[106:107], v[56:57], v[186:187] op_sel:[0,0,0] op_sel_hi:[0,1,1] neg_lo:[0,0,1] neg_hi:[0,0,1]
    v_pk_mul_f32 v[188:189], v[106:107], v[90:91] op_sel:[1,0] op_sel_hi:[1,1]
    v_pk_mul_f32 v[90:91], v[106:107], v[90:91] op_sel:[0,0] op_sel_hi:[0,1]
    v_pk_fma_f32 v[90:91], v[106:107], v[58:59], v[90:91] op_sel:[1,0,0] op_sel_hi:[1,1,1]
    v_pk_fma_f32 v[58:59], v[106:107], v[58:59], v[188:189] op_sel:[0,0,0] op_sel_hi:[0,1,1] neg_lo:[0,0,1] neg_hi:[0,0,1]
    s_add_u32 m0, s58, 32768
    s_xor_b32 s55, s3, 0
    buffer_load_dwordx4 v252, s[20:23], s55 offen lds
    v_pk_mul_f32 v[186:187], v[106:107], v[92:93] op_sel:[1,0] op_sel_hi:[1,1]
    v_pk_mul_f32 v[92:93], v[106:107], v[92:93] op_sel:[0,0] op_sel_hi:[0,1]
    v_pk_fma_f32 v[92:93], v[106:107], v[60:61], v[92:93] op_sel:[1,0,0] op_sel_hi:[1,1,1]
    v_pk_fma_f32 v[60:61], v[106:107], v[60:61], v[186:187] op_sel:[0,0,0] op_sel_hi:[0,1,1] neg_lo:[0,0,1] neg_hi:[0,0,1]
    v_pk_mul_f32 v[188:189], v[106:107], v[94:95] op_sel:[1,0] op_sel_hi:[1,1]
    v_pk_mul_f32 v[94:95], v[106:107], v[94:95] op_sel:[0,0] op_sel_hi:[0,1]
    v_pk_fma_f32 v[94:95], v[106:107], v[62:63], v[94:95] op_sel:[1,0,0] op_sel_hi:[1,1,1]
    v_pk_fma_f32 v[62:63], v[106:107], v[62:63], v[188:189] op_sel:[0,0,0] op_sel_hi:[0,1,1] neg_lo:[0,0,1] neg_hi:[0,0,1]
    v_mul_f32_dpp v186, v96, v131 row_ror:8 row_mask:0xf bank_mask:0xf
    v_mul_f32_dpp v187, v97, v131 row_ror:8 row_mask:0xf bank_mask:0xf
    v_pk_fma_f32 v[96:97], v[130:131], v[96:97], v[186:187] op_sel:[0,0,0] op_sel_hi:[0,1,1]
    buffer_load_dwordx4 v253, s[20:23], s55 offen offset:1024 lds
    v_mul_f32_dpp v188, v98, v131 row_ror:8 row_mask:0xf bank_mask:0xf
    v_mul_f32_dpp v189, v99, v131 row_ror:8 row_mask:0xf bank_mask:0xf
    v_pk_fma_f32 v[98:99], v[130:131], v[98:99], v[188:189] op_sel:[0,0,0] op_sel_hi:[0,1,1]
    v_mul_f32_dpp v186, v100, v131 row_ror:8 row_mask:0xf bank_mask:0xf
    v_mul_f32_dpp v187, v101, v131 row_ror:8 row_mask:0xf bank_mask:0xf
    v_pk_fma_f32 v[100:101], v[130:131], v[100:101], v[186:187] op_sel:[0,0,0] op_sel_hi:[0,1,1]
    v_mul_f32_dpp v188, v102, v131 row_ror:8 row_mask:0xf bank_mask:0xf
    v_mul_f32_dpp v189, v103, v131 row_ror:8 row_mask:0xf bank_mask:0xf
    v_pk_fma_f32 v[102:103], v[130:131], v[102:103], v[188:189] op_sel:[0,0,0] op_sel_hi:[0,1,1]
    v_pk_mul_f32 v[164:165], v[106:107], v[160:161] op_sel:[0,0] op_sel_hi:[0,1]
    v_pk_mul_f32 v[166:167], v[106:107], v[162:163] op_sel:[0,0] op_sel_hi:[0,1]
    buffer_load_dwordx4 v254, s[20:23], s55 offen offset:2048 lds
    v_pk_fma_f32 v[164:165], v[106:107], v[162:163], v[164:165] op_sel:[1,0,0] op_sel_hi:[1,1,1] neg_lo:[1,0,0] neg_hi:[1,0,0]
    v_pk_fma_f32 v[166:167], v[106:107], v[160:161], v[166:167] op_sel:[1,0,0] op_sel_hi:[1,1,1]
    s_waitcnt lgkmcnt(2)
    v_pk_fma_f32 v[178:179], v[148:149], v[176:177], v[178:179] op_sel:[0,0,0] op_sel_hi:[0,1,1]
    v_fma_f32 v160, v120, v164, v165
    s_nop 0
    v_fmac_f32_dpp v178, v176, v149 row_ror:8 row_mask:0xf bank_mask:0xf
    v_fma_f32 v162, v120, v166, v167
    v_fmac_f32_dpp v179, v177, v149 row_ror:8 row_mask:0xf bank_mask:0xf
    v_fma_f32 v160, -v121, v166, v160
    s_waitcnt lgkmcnt(1)
    v_pk_fma_f32 v[180:181], v[148:149], v[178:179], v[180:181] op_sel:[0,0,0] op_sel_hi:[0,1,1]
    v_fma_f32 v162, v121, v164, v162
    s_nop 0
    v_fmac_f32_dpp v180, v178, v149 row_ror:8 row_mask:0xf bank_mask:0xf
    buffer_load_dwordx4 v255, s[20:23], s55 offen offset:3072 lds
    v_mov_b32 v161, v160
    v_fmac_f32_dpp v181, v179, v149 row_ror:8 row_mask:0xf bank_mask:0xf
    v_mov_b32 v163, v162
    s_waitcnt lgkmcnt(0)
    v_pk_fma_f32 v[182:183], v[148:149], v[180:181], v[182:183] op_sel:[0,0,0] op_sel_hi:[0,1,1]
    v_permlane16_swap_b32 v160, v161
    s_nop 0
    v_fmac_f32_dpp v182, v180, v149 row_ror:8 row_mask:0xf bank_mask:0xf
    v_permlane16_swap_b32 v162, v163
    v_fmac_f32_dpp v183, v181, v149 row_ror:8 row_mask:0xf bank_mask:0xf
    v_fma_f32 v161, v122, v160, v161
    v_mov_b32 v174, 0
    v_fma_f32 v163, v122, v162, v163
    s_mov_b32 s76, 0
    s_waitcnt vmcnt(10)
    v_cmp_gt_u32 vcc, 4, v194
    s_cbranch_vccnz L_clr_loop
L_clr_ok:
    buffer_load_dwordx2 v[228:229], v22, s[40:43], 0 offen sc1
    buffer_load_dwordx4 v[208:211], v26, s[40:43], 0 offen sc1
    buffer_load_dwordx2 v[230:231], v23, s[40:43], 0 offen sc1
    buffer_load_dwordx4 v[212:215], v27, s[40:43], 0 offen sc1
    buffer_load_dwordx2 v[232:233], v24, s[40:43], 0 offen sc1
    buffer_load_dwordx4 v[216:219], v28, s[40:43], 0 offen sc1
    buffer_load_dwordx2 v[234:235], v25, s[40:43], 0 offen sc1
    buffer_load_dwordx4 v[220:223], v29, s[40:43], 0 offen sc1
    v_mov_b32 v175, 0
    s_add_u32 m0, s58, 65536
    s_xor_b32 s55, s3, 0
    buffer_load_dwordx4 v252, s[24:27], s55 offen lds
    v_fma_f32 v161, -v123, v162, v161
    s_cmp_eq_u32 s51, 1
    s_cselect_b64 vcc, -1, 0
    v_cndmask_b32 v174, v174, v176, vcc
    v_cndmask_b32 v175, v175, v177, vcc
    v_fma_f32 v163, v123, v160, v163
    s_cmp_eq_u32 s51, 2
    s_cselect_b64 vcc, -1, 0
    v_cndmask_b32 v174, v174, v178, vcc
    v_cndmask_b32 v175, v175, v179, vcc
    v_mov_b32 v165, v161
    buffer_load_dwordx4 v253, s[24:27], s55 offen offset:1024 lds
    s_cmp_eq_u32 s51, 3
    s_cselect_b64 vcc, -1, 0
    v_cndmask_b32 v174, v174, v180, vcc
    v_cndmask_b32 v175, v175, v181, vcc
    v_mov_b32 v167, v163
    v_fmac_f32 v183, v144, v182
    v_permlane32_swap_b32 v161, v165
    s_nop 0
    v_fmac_f32_dpp v183, v182, v145 row_ror:8 row_mask:0xf bank_mask:0xf
    buffer_load_dwordx4 v254, s[24:27], s55 offen offset:2048 lds
    v_permlane32_swap_b32 v163, v167
    v_mov_b32 v176, v183
    v_mul_f32 v156, v126, v160
    v_mov_b32 v177, v183
    v_mul_f32 v158, v126, v162
    buffer_load_dwordx4 v255, s[24:27], s55 offen offset:3072 lds
    v_permlane16_swap_b32 v176, v177
    v_fma_f32 v156, v124, v161, v156
    v_fmac_f32 v177, v146, v176
    v_fma_f32 v158, v124, v163, v158
    s_nop 0
    v_fmac_f32_dpp v177, v176, v147 row_ror:8 row_mask:0xf bank_mask:0xf
    s_add_u32 m0, s62, 0
    s_xor_b32 s55, s3, 0
    buffer_load_dwordx4 v11, s[44:47], s55 offen lds
    v_fma_f32 v156, -v125, v163, v156
    v_mov_b32 v180, v177
    v_fma_f32 v158, v125, v161, v158
    s_nop 0
    v_permlane32_swap_b32 v177, v180
    v_fma_f32 v157, v120, v156, v164
    s_add_u32 m0, s62, 8192
    s_bfe_u32 s55, s1, 524296
    s_lshl_b32 s55, s55, 7
    buffer_load_dwordx4 v11, s[44:47], s55 offen lds
    v_mul_f32 v178, v126, v176
    v_fma_f32 v159, v120, v158, v166
    v_fmac_f32 v178, v152, v177
    v_fma_f32 v157, -v121, v158, v157
    s_nop 0
    v_fmac_f32_dpp v178, v177, v153 row_ror:8 row_mask:0xf bank_mask:0xf
    s_add_u32 m0, s62, 12288
    s_bfe_u32 s55, s1, 524304
    s_lshl_b32 s55, s55, 7
    buffer_load_dwordx4 v11, s[44:47], s55 offen lds
    v_fma_f32 v159, v121, v156, v159
    v_mov_b32 v179, v182
    v_fmac_f32 v179, v144, v178
    s_nop 1
    v_fmac_f32_dpp v179, v178, v145 row_ror:8 row_mask:0xf bank_mask:0xf
    v_pk_fma_f32 v[174:175], v[150:151], v[178:179], v[174:175] op_sel:[0,0,0] op_sel_hi:[0,1,1]
    s_add_u32 m0, s62, 16384
    s_bfe_u32 s55, s1, 524312
    s_lshl_b32 s55, s55, 7
    buffer_load_dwordx4 v11, s[44:47], s55 offen lds
    v_fmac_f32_dpp v174, v178, v151 row_ror:8 row_mask:0xf bank_mask:0xf
    v_fmac_f32_dpp v175, v179, v151 row_ror:8 row_mask:0xf bank_mask:0xf
    v_mov_b32 v120, v174
    v_mov_b32 v121, v175
    s_waitcnt vmcnt(8)
    v_max3_u32 v236, v228, v229, v230
    v_max3_u32 v237, v231, v232, v233
    v_max3_u32 v236, v236, v234, v235
    v_max3_u32 v237, v237, v208, v209
    v_max3_u32 v236, v236, v210, v211
    v_max3_u32 v237, v237, v212, v213
    v_max3_u32 v236, v236, v214, v215
    v_max3_u32 v237, v237, v216, v217
    v_max3_u32 v236, v236, v218, v219
    v_max3_u32 v237, v237, v220, v221
    v_max3_u32 v236, v236, v222, v223
    v_max_u32 v236, v236, v237
    v_cmp_eq_u32 vcc, -1, v236
    s_cbranch_vccnz L_g_retry
L_g_ok:
.p2align 3
    v_pk_add_f32 v[220:221], v[220:221], v[222:223]
    v_pk_add_f32 v[216:217], v[216:217], v[218:219]
    v_pk_fma_f32 v[232:233], v[112:113], v[234:235], v[232:233] op_sel:[0,0,0] op_sel_hi:[0,1,1]
    v_pk_add_f32 v[212:213], v[212:213], v[214:215]
    v_pk_fma_f32 v[232:233], v[112:113], v[234:235], v[232:233] op_sel:[1,1,0] op_sel_hi:[1,0,1] neg_lo:[1,0,0]
    v_pk_add_f32 v[208:209], v[208:209], v[210:211]
    v_pk_fma_f32 v[230:231], v[112:113], v[232:233], v[230:231] op_sel:[0,0,0] op_sel_hi:[0,1,1]
    v_pk_fma_f32 v[216:217], v[136:137], v[220:221], v[216:217] op_sel:[0,0,0] op_sel_hi:[0,1,1]
    v_pk_fma_f32 v[230:231], v[112:113], v[232:233], v[230:231] op_sel:[1,1,0] op_sel_hi:[1,0,1] neg_lo:[1,0,0]
    v_pk_fma_f32 v[216:217], v[136:137], v[220:221], v[216:217] op_sel:[1,1,0] op_sel_hi:[1,0,1] neg_lo:[1,0,0]
    v_pk_fma_f32 v[228:229], v[112:113], v[230:231], v[228:229] op_sel:[0,0,0] op_sel_hi:[0,1,1]
    v_pk_fma_f32 v[212:213], v[136:137], v[216:217], v[212:213] op_sel:[0,0,0] op_sel_hi:[0,1,1]
    v_pk_fma_f32 v[228:229], v[112:113], v[230:231], v[228:229] op_sel:[1,1,0] op_sel_hi:[1,0,1] neg_lo:[1,0,0]
    v_pk_fma_f32 v[212:213], v[136:137], v[216:217], v[212:213] op_sel:[1,1,0] op_sel_hi:[1,0,1] neg_lo:[1,0,0]
    v_pk_mul_f32 v[230:231], v[114:115], v[228:229] op_sel:[0,0] op_sel_hi:[0,1]
    v_pk_fma_f32 v[208:209], v[136:137], v[212:213], v[208:209] op_sel:[0,0,0] op_sel_hi:[0,1,1]
    v_pk_fma_f32 v[230:231], v[114:115], v[228:229], v[230:231] op_sel:[1,1,0] op_sel_hi:[1,0,1] neg_lo:[1,0,0]
    v_pk_fma_f32 v[208:209], v[136:137], v[212:213], v[208:209] op_sel:[1,1,0] op_sel_hi:[1,0,1] neg_lo:[1,0,0]
    v_pk_mul_f32 v[212:213], v[138:139], v[208:209] op_sel:[0,0] op_sel_hi:[0,1]
    v_pk_fma_f32 v[212:213], v[138:139], v[208:209], v[212:213] op_sel:[1,1,0] op_sel_hi:[1,0,1] neg_lo:[1,0,0]
    v_permlane16_swap_b32 v230, v231
    s_nop 0
    v_permlane16_swap_b32 v212, v213
    v_add_f32 v230, v230, v231
    v_add_f32 v212, v212, v213
    s_nop 1
    v_permlane32_swap_b32 v230, v212
    v_add_f32 v232, v230, v212
    v_add_f32 v234, v230, v212
    s_nop 1
    v_permlane32_swap_b32 v232, v234
    v_mov_b32 v233, v232
    s_nop 0
    v_add_f32_dpp v235, v234, v234 row_ror:8 row_mask:0xf bank_mask:0xf
    v_add_f32_dpp v234, v234, v234 row_ror:8 row_mask:0xf bank_mask:0xf
    v_permlane16_swap_b32 v232, v233
    s_nop 0
    v_permlane16_swap_b32 v234, v235
    v_pk_fma_f32 v[156:157], v[116:117], v[232:233], v[156:157] op_sel:[0,0,0] op_sel_hi:[1,0,1]
    v_pk_fma_f32 v[158:159], v[116:117], v[232:233], v[158:159] op_sel:[0,1,0] op_sel_hi:[1,1,1]
    v_pk_fma_f32 v[156:157], v[118:119], v[232:233], v[156:157] op_sel:[0,1,0] op_sel_hi:[1,1,1] neg_lo:[1,0,0] neg_hi:[1,0,0]
    v_pk_fma_f32 v[158:159], v[118:119], v[232:233], v[158:159] op_sel:[0,0,0] op_sel_hi:[1,0,1]
    v_pk_fma_f32 v[120:121], v[140:141], v[234:235], v[120:121] op_sel:[0,0,0] op_sel_hi:[1,0,1]
    v_pk_fma_f32 v[120:121], v[142:143], v[234:235], v[120:121] op_sel:[0,1,0] op_sel_hi:[1,1,1]
.p2align 3
    v_pk_fma_f32 v[32:33], v[104:105], v[156:157], v[32:33] op_sel:[0,0,0] op_sel_hi:[0,1,1]
    v_pk_fma_f32 v[64:65], v[104:105], v[158:159], v[64:65] op_sel:[0,0,0] op_sel_hi:[0,1,1]
    v_pk_fma_f32 v[96:97], v[128:129], v[120:121], v[96:97] op_sel:[0,0,0] op_sel_hi:[0,1,1]
    v_pk_fma_f32 v[32:33], v[104:105], v[158:159], v[32:33] op_sel:[1,0,0] op_sel_hi:[1,1,1] neg_lo:[1,0,0] neg_hi:[1,0,0]
    v_pk_fma_f32 v[64:65], v[104:105], v[156:157], v[64:65] op_sel:[1,0,0] op_sel_hi:[1,1,1]
    v_pk_fma_f32 v[34:35], v[104:105], v[32:33], v[34:35] op_sel:[0,0,0] op_sel_hi:[0,1,1]
    v_fmac_f32_dpp v96, v120, v129 row_ror:8 row_mask:0xf bank_mask:0xf
    v_pk_fma_f32 v[66:67], v[104:105], v[64:65], v[66:67] op_sel:[0,0,0] op_sel_hi:[0,1,1]
    v_pk_fma_f32 v[34:35], v[104:105], v[64:65], v[34:35] op_sel:[1,0,0] op_sel_hi:[1,1,1] neg_lo:[1,0,0] neg_hi:[1,0,0]
    v_pk_fma_f32 v[66:67], v[104:105], v[32:33], v[66:67] op_sel:[1,0,0] op_sel_hi:[1,1,1]
    v_fmac_f32_dpp v97, v121, v129 row_ror:8 row_mask:0xf bank_mask:0xf
    v_pk_fma_f32 v[36:37], v[104:105], v[34:35], v[36:37] op_sel:[0,0,0] op_sel_hi:[0,1,1]
    v_pk_fma_f32 v[68:69], v[104:105], v[66:67], v[68:69] op_sel:[0,0,0] op_sel_hi:[0,1,1]
    v_pk_fma_f32 v[36:37], v[104:105], v[66:67], v[36:37] op_sel:[1,0,0] op_sel_hi:[1,1,1] neg_lo:[1,0,0] neg_hi:[1,0,0]
    v_pk_fma_f32 v[98:99], v[128:129], v[96:97], v[98:99] op_sel:[0,0,0] op_sel_hi:[0,1,1]
    v_pk_fma_f32 v[68:69], v[104:105], v[34:35], v[68:69] op_sel:[1,0,0] op_sel_hi:[1,1,1]
    v_pk_fma_f32 v[38:39], v[104:105], v[36:37], v[38:39] op_sel:[0,0,0] op_sel_hi:[0,1,1]
    v_pk_fma_f32 v[70:71], v[104:105], v[68:69], v[70:71] op_sel:[0,0,0] op_sel_hi:[0,1,1]
    v_fmac_f32_dpp v98, v96, v129 row_ror:8 row_mask:0xf bank_mask:0xf
    v_pk_fma_f32 v[38:39], v[104:105], v[68:69], v[38:39] op_sel:[1,0,0] op_sel_hi:[1,1,1] neg_lo:[1,0,0] neg_hi:[1,0,0]
    v_pk_fma_f32 v[70:71], v[104:105], v[36:37], v[70:71] op_sel:[1,0,0] op_sel_hi:[1,1,1]
    v_cvt_pk_bf16_f32 v32, v32, v33
    v_fmac_f32_dpp v99, v97, v129 row_ror:8 row_mask:0xf bank_mask:0xf
    v_cvt_pk_bf16_f32 v33, v34, v35
    v_cvt_pk_bf16_f32 v34, v36, v37
    v_cvt_pk_bf16_f32 v35, v38, v39
    v_pk_fma_f32 v[100:101], v[128:129], v[98:99], v[100:101] op_sel:[0,0,0] op_sel_hi:[0,1,1]
    buffer_store_dwordx4 v[32:35], v30, s[28:31], 0 offen offset:0 sc1
    v_pk_fma_f32 v[40:41], v[104:105], v[38:39], v[40:41] op_sel:[0,0,0] op_sel_hi:[0,1,1]
    v_pk_fma_f32 v[72:73], v[104:105], v[70:71], v[72:73] op_sel:[0,0,0] op_sel_hi:[0,1,1]
    v_fmac_f32_dpp v100, v98, v129 row_ror:8 row_mask:0xf bank_mask:0xf
    v_pk_fma_f32 v[40:41], v[104:105], v[70:71], v[40:41] op_sel:[1,0,0] op_sel_hi:[1,1,1] neg_lo:[1,0,0] neg_hi:[1,0,0]
    v_pk_fma_f32 v[72:73], v[104:105], v[38:39], v[72:73] op_sel:[1,0,0] op_sel_hi:[1,1,1]
    v_pk_fma_f32 v[42:43], v[104:105], v[40:41], v[42:43] op_sel:[0,0,0] op_sel_hi:[0,1,1]
    v_fmac_f32_dpp v101, v99, v129 row_ror:8 row_mask:0xf bank_mask:0xf
    v_pk_fma_f32 v[74:75], v[104:105], v[72:73], v[74:75] op_sel:[0,0,0] op_sel_hi:[0,1,1]
    v_pk_fma_f32 v[42:43], v[104:105], v[72:73], v[42:43] op_sel:[1,0,0] op_sel_hi:[1,1,1] neg_lo:[1,0,0] neg_hi:[1,0,0]
    v_pk_fma_f32 v[74:75], v[104:105], v[40:41], v[74:75] op_sel:[1,0,0] op_sel_hi:[1,1,1]
    v_pk_fma_f32 v[102:103], v[128:129], v[100:101], v[102:103] op_sel:[0,0,0] op_sel_hi:[0,1,1]
    v_pk_fma_f32 v[44:45], v[104:105], v[42:43], v[44:45] op_sel:[0,0,0] op_sel_hi:[0,1,1]
    v_pk_fma_f32 v[76:77], v[104:105], v[74:75], v[76:77] op_sel:[0,0,0] op_sel_hi:[0,1,1]
    v_pk_fma_f32 v[44:45], v[104:105], v[74:75], v[44:45] op_sel:[1,0,0] op_sel_hi:[1,1,1] neg_lo:[1,0,0] neg_hi:[1,0,0]
    v_fmac_f32_dpp v102, v100, v129 row_ror:8 row_mask:0xf bank_mask:0xf
    v_pk_fma_f32 v[76:77], v[104:105], v[42:43], v[76:77] op_sel:[1,0,0] op_sel_hi:[1,1,1]
    v_pk_fma_f32 v[46:47], v[104:105], v[44:45], v[46:47] op_sel:[0,0,0] op_sel_hi:[0,1,1]
    v_pk_fma_f32 v[78:79], v[104:105], v[76:77], v[78:79] op_sel:[0,0,0] op_sel_hi:[0,1,1]
    v_fmac_f32_dpp v103, v101, v129 row_ror:8 row_mask:0xf bank_mask:0xf
    v_pk_fma_f32 v[46:47], v[104:105], v[76:77], v[46:47] op_sel:[1,0,0] op_sel_hi:[1,1,1] neg_lo:[1,0,0] neg_hi:[1,0,0]
    v_pk_fma_f32 v[78:79], v[104:105], v[44:45], v[78:79] op_sel:[1,0,0] op_sel_hi:[1,1,1]
    v_cvt_pk_bf16_f32 v40, v40, v41
    v_pk_mul_f32 v[96:97], v[96:97], v[154:155] op_sel:[0,0] op_sel_hi:[1,0]
    v_cvt_pk_bf16_f32 v41, v42, v43
    v_cvt_pk_bf16_f32 v42, v44, v45
    v_cvt_pk_bf16_f32 v43, v46, v47
    v_pk_mul_f32 v[98:99], v[98:99], v[154:155] op_sel:[0,0] op_sel_hi:[1,0]
    buffer_store_dwordx4 v[40:43], v30, s[28:31], 0 offen offset:1024 sc1
    v_pk_fma_f32 v[48:49], v[104:105], v[46:47], v[48:49] op_sel:[0,0,0] op_sel_hi:[0,1,1]
    v_pk_fma_f32 v[80:81], v[104:105], v[78:79], v[80:81] op_sel:[0,0,0] op_sel_hi:[0,1,1]
    v_pk_mul_f32 v[100:101], v[100:101], v[154:155] op_sel:[0,0] op_sel_hi:[1,0]
    v_pk_fma_f32 v[48:49], v[104:105], v[78:79], v[48:49] op_sel:[1,0,0] op_sel_hi:[1,1,1] neg_lo:[1,0,0] neg_hi:[1,0,0]
    v_pk_fma_f32 v[80:81], v[104:105], v[46:47], v[80:81] op_sel:[1,0,0] op_sel_hi:[1,1,1]
    v_pk_fma_f32 v[50:51], v[104:105], v[48:49], v[50:51] op_sel:[0,0,0] op_sel_hi:[0,1,1]
    v_pk_mul_f32 v[102:103], v[102:103], v[154:155] op_sel:[0,0] op_sel_hi:[1,0]
    v_pk_fma_f32 v[82:83], v[104:105], v[80:81], v[82:83] op_sel:[0,0,0] op_sel_hi:[0,1,1]
    v_pk_fma_f32 v[50:51], v[104:105], v[80:81], v[50:51] op_sel:[1,0,0] op_sel_hi:[1,1,1] neg_lo:[1,0,0] neg_hi:[1,0,0]
    v_pk_fma_f32 v[82:83], v[104:105], v[48:49], v[82:83] op_sel:[1,0,0] op_sel_hi:[1,1,1]
    v_cvt_pk_bf16_f32 v96, -v96, -v97
    v_pk_fma_f32 v[52:53], v[104:105], v[50:51], v[52:53] op_sel:[0,0,0] op_sel_hi:[0,1,1]
    v_pk_fma_f32 v[84:85], v[104:105], v[82:83], v[84:85] op_sel:[0,0,0] op_sel_hi:[0,1,1]
    v_pk_fma_f32 v[52:53], v[104:105], v[82:83], v[52:53] op_sel:[1,0,0] op_sel_hi:[1,1,1] neg_lo:[1,0,0] neg_hi:[1,0,0]
    v_cvt_pk_bf16_f32 v97, -v98, -v99
    v_pk_fma_f32 v[84:85], v[104:105], v[50:51], v[84:85] op_sel:[1,0,0] op_sel_hi:[1,1,1]
    v_pk_fma_f32 v[54:55], v[104:105], v[52:53], v[54:55] op_sel:[0,0,0] op_sel_hi:[0,1,1]
    v_pk_fma_f32 v[86:87], v[104:105], v[84:85], v[86:87] op_sel:[0,0,0] op_sel_hi:[0,1,1]
    v_cvt_pk_bf16_f32 v98, -v100, -v101
    v_pk_fma_f32 v[54:55], v[104:105], v[84:85], v[54:55] op_sel:[1,0,0] op_sel_hi:[1,1,1] neg_lo:[1,0,0] neg_hi:[1,0,0]
    v_pk_fma_f32 v[86:87], v[104:105], v[52:53], v[86:87] op_sel:[1,0,0] op_sel_hi:[1,1,1]
    v_cvt_pk_bf16_f32 v48, v48, v49
    v_cvt_pk_bf16_f32 v99, -v102, -v103
    v_cvt_pk_bf16_f32 v49, v50, v51
    v_cvt_pk_bf16_f32 v50, v52, v53
    v_cvt_pk_bf16_f32 v51, v54, v55
    buffer_store_dwordx4 v[96:99], v31, s[28:31], 0 offen sc1
    buffer_store_dwordx4 v[48:51], v30, s[28:31], s78 offen offset:0 sc1
    v_pk_fma_f32 v[56:57], v[104:105], v[54:55], v[56:57] op_sel:[0,0,0] op_sel_hi:[0,1,1]
    v_pk_fma_f32 v[88:89], v[104:105], v[86:87], v[88:89] op_sel:[0,0,0] op_sel_hi:[0,1,1]
    v_pk_fma_f32 v[56:57], v[104:105], v[86:87], v[56:57] op_sel:[1,0,0] op_sel_hi:[1,1,1] neg_lo:[1,0,0] neg_hi:[1,0,0]
    v_pk_fma_f32 v[88:89], v[104:105], v[54:55], v[88:89] op_sel:[1,0,0] op_sel_hi:[1,1,1]
    v_pk_fma_f32 v[58:59], v[104:105], v[56:57], v[58:59] op_sel:[0,0,0] op_sel_hi:[0,1,1]
    v_pk_fma_f32 v[90:91], v[104:105], v[88:89], v[90:91] op_sel:[0,0,0] op_sel_hi:[0,1,1]
    v_pk_fma_f32 v[58:59], v[104:105], v[88:89], v[58:59] op_sel:[1,0,0] op_sel_hi:[1,1,1] neg_lo:[1,0,0] neg_hi:[1,0,0]
    v_pk_fma_f32 v[90:91], v[104:105], v[56:57], v[90:91] op_sel:[1,0,0] op_sel_hi:[1,1,1]
    v_pk_fma_f32 v[60:61], v[104:105], v[58:59], v[60:61] op_sel:[0,0,0] op_sel_hi:[0,1,1]
    v_pk_fma_f32 v[92:93], v[104:105], v[90:91], v[92:93] op_sel:[0,0,0] op_sel_hi:[0,1,1]
    v_pk_fma_f32 v[60:61], v[104:105], v[90:91], v[60:61] op_sel:[1,0,0] op_sel_hi:[1,1,1] neg_lo:[1,0,0] neg_hi:[1,0,0]
    v_pk_fma_f32 v[92:93], v[104:105], v[58:59], v[92:93] op_sel:[1,0,0] op_sel_hi:[1,1,1]
    v_pk_fma_f32 v[62:63], v[104:105], v[60:61], v[62:63] op_sel:[0,0,0] op_sel_hi:[0,1,1]
    v_pk_fma_f32 v[62:63], v[104:105], v[92:93], v[62:63] op_sel:[1,0,0] op_sel_hi:[1,1,1] neg_lo:[1,0,0] neg_hi:[1,0,0]
    v_cvt_pk_bf16_f32 v56, v56, v57
    v_cvt_pk_bf16_f32 v57, v58, v59
    v_cvt_pk_bf16_f32 v58, v60, v61
    v_cvt_pk_bf16_f32 v59, v62, v63
    buffer_store_dwordx4 v[56:59], v30, s[28:31], s78 offen offset:1024 sc1
    v_pk_fma_f32 v[94:95], v[104:105], v[92:93], v[94:95] op_sel:[0,0,0] op_sel_hi:[0,1,1]
    v_pk_fma_f32 v[94:95], v[104:105], v[60:61], v[94:95] op_sel:[1,0,0] op_sel_hi:[1,1,1]
    v_cvt_pk_bf16_f32 v64, -v64, -v65
    v_cvt_pk_bf16_f32 v65, -v66, -v67
    v_cvt_pk_bf16_f32 v66, -v68, -v69
    v_cvt_pk_bf16_f32 v67, -v70, -v71
    v_cvt_pk_bf16_f32 v72, -v72, -v73
    v_cvt_pk_bf16_f32 v73, -v74, -v75
    v_cvt_pk_bf16_f32 v74, -v76, -v77
    v_cvt_pk_bf16_f32 v75, -v78, -v79
    v_cvt_pk_bf16_f32 v80, -v80, -v81
    v_cvt_pk_bf16_f32 v81, -v82, -v83
    v_cvt_pk_bf16_f32 v82, -v84, -v85
    v_cvt_pk_bf16_f32 v83, -v86, -v87
    v_cvt_pk_bf16_f32 v88, -v88, -v89
    v_cvt_pk_bf16_f32 v89, -v90, -v91
    v_cvt_pk_bf16_f32 v90, -v92, -v93
    v_cvt_pk_bf16_f32 v91, -v94, -v95
    ds_read_b128 v[208:211], v251 offset:0
    ds_read_b128 v[212:215], v251 offset:1024
    ds_read_b128 v[216:219], v251 offset:2048
    ds_read_b128 v[220:223], v251 offset:3072
    ds_read_b128 v[224:227], v244
    buffer_store_dwordx4 v[64:67], v30, s[28:31], s77 offen offset:0 sc1
    s_cmp_eq_u32 s52, 1
    s_cbranch_scc1 L_lw1
    ds_write_b128 v242, v[32:35] offset:16384
    ds_write_b128 v242, v[64:67] offset:24576
    ds_write_b128 v242, v[40:43] offset:17408
    ds_write_b128 v242, v[72:75] offset:25600
L_lw_join:
    ds_read_b128 a[32:35], v19 offset:0
    ds_read_b128 a[36:39], v19 offset:2048
    ds_read_b128 a[40:43], v20 offset:0
    ds_read_b128 a[44:47], v20 offset:2048
    ds_read_b128 a[48:51], v15 offset:0
    ds_read_b128 a[52:55], v15 offset:2048
    ds_read_b128 a[56:59], v16 offset:0
    ds_read_b128 a[60:63], v16 offset:2048
    ds_read_b128 a[0:3], v19 offset:32768
    ds_read_b128 a[4:7], v19 offset:34816
    ds_read_b128 a[8:11], v20 offset:32768
    ds_read_b128 a[12:15], v20 offset:34816
    s_waitcnt vmcnt(10)
    ds_read_b128 a[16:19], v15 offset:16384
    ds_read_b128 a[20:23], v15 offset:18432
    ds_read_b128 a[24:27], v16 offset:16384
    ds_read_b128 a[28:31], v16 offset:18432
    s_waitcnt lgkmcnt(15)
    v_mfma_f32_16x16x32_bf16 v[160:163], v[208:211], v[196:199], 0
    v_mfma_f32_16x16x32_bf16 v[164:167], v[208:211], v[200:203], 0
    v_mfma_f32_16x16x32_bf16 v[168:171], v[212:215], v[196:199], 0
    v_mfma_f32_16x16x32_bf16 v[172:175], v[212:215], v[200:203], 0
    v_mfma_f32_16x16x32_bf16 v[176:179], v[216:219], v[196:199], 0
    v_mfma_f32_16x16x32_bf16 v[180:183], v[216:219], v[200:203], 0
    v_mfma_f32_16x16x32_bf16 v[184:187], v[220:223], v[196:199], 0
    v_mfma_f32_16x16x32_bf16 v[188:191], v[220:223], v[200:203], 0
    v_mfma_f32_16x16x32_bf16 v[192:195], v[224:227], v[204:207], 0
    s_waitcnt lgkmcnt(0)
    buffer_store_dwordx4 v[72:75], v30, s[28:31], s77 offen offset:1024 sc1
    v_add_u32 v17, 126976, v13
    v_add_u32 v18, 126976, v14
    v_lshrrev_b32 v229, 1, v2
    v_lshlrev_b32 v229, 11, v229
    v_lshrrev_b32 v230, 2, v3
    v_lshl_add_u32 v229, v230, 4, v229
    v_bfe_u32 v230, v3, 1, 1
    v_lshl_add_u32 v229, v230, 6, v229
    v_and_b32 v230, 1, v2
    v_lshl_add_u32 v229, v230, 7, v229
    v_and_b32 v230, 1, v3
    v_lshl_add_u32 v229, v230, 9, v229
    buffer_store_dwordx4 v[80:83], v30, s[28:31], s79 offen offset:0 sc1
    v_lshl_add_u32 v229, v230, 3, v229
    s_and_b32 s57, s51, 1
    s_lshl_b32 s57, s57, 3
    s_lshr_b32 s56, s51, 1
    s_lshl_b32 s56, s56, 10
    s_or_b32 s57, s57, s56
    v_xor_b32 v4, s57, v229
    v_xor_b32 v5, 8, v4
    v_xor_b32 v6, 0x400, v4
    v_xor_b32 v7, 0x408, v4
    v_and_b32 v230, 1, v2
    s_and_b32 s57, s51, 1
    buffer_store_dwordx4 v[88:91], v30, s[28:31], s79 offen offset:1024 sc1
    v_xor_b32 v230, s57, v230
    v_lshlrev_b32 v229, 5, v2
    v_lshl_add_u32 v8, v230, 1, v229
    v_xor_b32 v9, 2, v8
    v_mul_u32_u24 v8, 4608, v8
    v_mul_u32_u24 v9, 4608, v9
    s_mul_i32 s57, s49, 589824
    s_mul_i32 s56, s48, 2304
    s_add_u32 s57, s57, s56
    s_mul_i32 s56, s53, 576
    s_add_u32 s57, s57, s56
    v_lshlrev_b32 v229, 2, v3
    v_add_u32 v229, s57, v229
    v_add_u32 v10, v8, v229
    v_add_u32 v10, 512, v10
    s_lshl_b32 s56, s51, 7
    v_add3_u32 v8, v8, v229, s56
    v_add3_u32 v9, v9, v229, s56
    v_and_b32 v241, 11, v1
    v_lshlrev_b32 v241, 4, v241
    v_and_b32 v229, 1, v2
    v_lshl_add_u32 v241, v229, 6, v241
    v_lshrrev_b32 v229, 1, v2
    v_lshl_add_u32 v241, v229, 8, v241
    v_bfe_u32 v229, v1, 2, 1
    v_lshl_add_u32 v241, v229, 9, v241
    s_mov_b32 s76, 0
    s_add_u32 m0, s62, 20480
    s_xor_b32 s55, s3, 128
    buffer_load_dwordx4 v11, s[44:47], s55 offen lds
    s_add_u32 m0, s62, 24576
    s_xor_b32 s55, s3, 256
    buffer_load_dwordx4 v11, s[44:47], s55 offen lds
    s_add_u32 m0, s62, 28672
    s_xor_b32 s55, s3, 384
    buffer_load_dwordx4 v11, s[44:47], s55 offen lds
    s_add_u32 m0, s62, 32768
    s_mov_b32 s55, 1024
    buffer_load_dwordx4 v11, s[44:47], s55 offen lds
    s_add_u32 m0, s58, 81920
    s_bfe_u32 s55, s1, 524296
    s_lshl_b32 s55, s55, 7
    buffer_load_dwordx4 v252, s[20:23], s55 offen lds
    buffer_load_dwordx4 v253, s[20:23], s55 offen offset:1024 lds
    buffer_load_dwordx4 v254, s[20:23], s55 offen offset:2048 lds
    buffer_load_dwordx4 v255, s[20:23], s55 offen offset:3072 lds
    s_waitcnt vmcnt(8)
    s_barrier
    s_mov_b32 exec_lo, 0
    s_mov_b32 exec_hi, 0x10000
    buffer_store_dword v12, v21, s[28:31], 0 offen sc1
    s_mov_b64 exec, -1
    s_add_u32 m0, s58, 98304
    s_bfe_u32 s55, s1, 524296
    s_lshl_b32 s55, s55, 7
    buffer_load_dwordx4 v252, s[24:27], s55 offen lds
    buffer_load_dwordx4 v253, s[24:27], s55 offen offset:1024 lds
    buffer_load_dwordx4 v254, s[24:27], s55 offen offset:2048 lds
    buffer_load_dwordx4 v255, s[24:27], s55 offen offset:3072 lds
    s_add_u32 m0, s58, 0
    s_bfe_u32 s55, s1, 524304
    s_lshl_b32 s55, s55, 7
    buffer_load_dwordx4 v252, s[20:23], s55 offen lds
    buffer_load_dwordx4 v253, s[20:23], s55 offen offset:1024 lds
    buffer_load_dwordx4 v254, s[20:23], s55 offen offset:2048 lds
    buffer_load_dwordx4 v255, s[20:23], s55 offen offset:3072 lds
    s_add_u32 m0, s58, 65536
    s_bfe_u32 s55, s1, 524304
    s_lshl_b32 s55, s55, 7
    buffer_load_dwordx4 v252, s[24:27], s55 offen lds
    buffer_load_dwordx4 v253, s[24:27], s55 offen offset:1024 lds
    buffer_load_dwordx4 v254, s[24:27], s55 offen offset:2048 lds
    buffer_load_dwordx4 v255, s[24:27], s55 offen offset:3072 lds
    s_waitcnt vmcnt(13)
    ds_read_b128 a[64:67], v15 offset:32768
    ds_read_b128 a[68:71], v15 offset:34816
    ds_read_b128 a[72:75], v16 offset:32768
    ds_read_b128 a[76:79], v16 offset:34816
    s_waitcnt lgkmcnt(0)
    s_add_u32 m0, s58, 81920
    s_bfe_u32 s55, s1, 524312
    s_lshl_b32 s55, s55, 7
    buffer_load_dwordx4 v252, s[20:23], s55 offen lds
    buffer_load_dwordx4 v253, s[20:23], s55 offen offset:1024 lds
    buffer_load_dwordx4 v254, s[20:23], s55 offen offset:2048 lds
    buffer_load_dwordx4 v255, s[20:23], s55 offen offset:3072 lds
    s_waitcnt vmcnt(12)
    ds_read_b128 a[80:83], v15 offset:49152
    ds_read_b128 a[84:87], v15 offset:51200
    ds_read_b128 a[88:91], v16 offset:49152
    ds_read_b128 a[92:95], v16 offset:51200
    s_waitcnt lgkmcnt(0)
    s_add_u32 m0, s58, 98304
    s_bfe_u32 s55, s1, 524312
    s_lshl_b32 s55, s55, 7
    buffer_load_dwordx4 v252, s[24:27], s55 offen lds
    buffer_load_dwordx4 v253, s[24:27], s55 offen offset:1024 lds
    buffer_load_dwordx4 v254, s[24:27], s55 offen offset:2048 lds
    buffer_load_dwordx4 v255, s[24:27], s55 offen offset:3072 lds
    s_waitcnt vmcnt(12)
    ds_read_b128 a[96:99], v19 offset:0
    ds_read_b128 a[100:103], v19 offset:2048
    ds_read_b128 a[104:107], v20 offset:0
    ds_read_b128 a[108:111], v20 offset:2048
    s_cmp_eq_u32 s51, 0
    s_cbranch_scc1 L_f_loop
L_f_ok:
    s_waitcnt lgkmcnt(0)
    s_barrier
    s_add_u32 m0, s58, 32768
    s_bfe_u32 s54, s1, 524288
    s_lshl_b32 s54, s54, 7
    s_lshl_b32 s54, s54, 6
    s_add_u32 s54, s54, s63
    buffer_load_dwordx4 v241, s[28:31], s54 offen sc1 lds
    buffer_load_dwordx4 v241, s[28:31], s54 offen offset:1024 sc1 lds
    buffer_load_dwordx4 v241, s[28:31], s54 offen offset:2048 sc1 lds
    buffer_load_dwordx4 v241, s[28:31], s54 offen offset:3072 sc1 lds
    s_add_u32 m0, s58, 49152
    s_bfe_u32 s54, s1, 524296
    s_lshl_b32 s54, s54, 7
    s_lshl_b32 s54, s54, 6
    s_add_u32 s54, s54, s63
    buffer_load_dwordx4 v241, s[28:31], s54 offen sc1 lds
    buffer_load_dwordx4 v241, s[28:31], s54 offen offset:1024 sc1 lds
    buffer_load_dwordx4 v241, s[28:31], s54 offen offset:2048 sc1 lds
    buffer_load_dwordx4 v241, s[28:31], s54 offen offset:3072 sc1 lds
    ds_read_b64_tr_b16 v[32:33], v4 offset:16384
    ds_read_b64_tr_b16 v[34:35], v4 offset:16640
    ds_read_b64_tr_b16 v[36:37], v5 offset:16384
    ds_read_b64_tr_b16 v[38:39], v5 offset:16640
    ds_read_b64_tr_b16 v[40:41], v6 offset:16384
    ds_read_b64_tr_b16 v[42:43], v6 offset:16640
    ds_read_b64_tr_b16 v[44:45], v7 offset:16384
    ds_read_b64_tr_b16 v[46:47], v7 offset:16640
    ds_read_b128 v[144:147], v17 offset:0
    ds_read_b64_tr_b16 v[48:49], v4 offset:20480
    ds_read_b64_tr_b16 v[50:51], v4 offset:20736
    ds_read_b64_tr_b16 v[52:53], v5 offset:20480
    ds_read_b64_tr_b16 v[54:55], v5 offset:20736
    ds_read_b64_tr_b16 v[56:57], v6 offset:20480
    ds_read_b64_tr_b16 v[58:59], v6 offset:20736
    ds_read_b64_tr_b16 v[60:61], v7 offset:20480
    ds_read_b64_tr_b16 v[62:63], v7 offset:20736
    ds_read_b128 v[148:151], v18 offset:0
    s_waitcnt lgkmcnt(9)
    v_mfma_f32_16x16x32_bf16 v[192:195], v[32:35], v[144:147], v[192:195]
    s_waitcnt vmcnt(16)
    ds_read_b128 a[112:115], v15 offset:16384
    v_mfma_f32_16x16x32_bf16 v[160:163], v[32:35], a[0:3], v[160:163]
    ds_read_b128 a[116:119], v15 offset:18432
    ds_read_b128 a[120:123], v16 offset:16384
    v_mfma_f32_16x16x32_bf16 v[164:167], v[32:35], a[4:7], v[164:167]
    ds_read_b128 a[124:127], v16 offset:18432
    ds_read_b64_tr_b16 v[128:129], v4 offset:24576
    s_add_u32 m0, s58, 0
    s_bfe_u32 s54, s1, 524304
    s_lshl_b32 s54, s54, 7
    s_lshl_b32 s54, s54, 6
    s_add_u32 s54, s54, s63
    buffer_load_dwordx4 v241, s[28:31], s54 offen sc1 lds
    v_mfma_f32_16x16x32_bf16 v[168:171], v[36:39], a[0:3], v[168:171]
    ds_read_b64_tr_b16 v[130:131], v4 offset:24832
    ds_read_b64_tr_b16 v[132:133], v5 offset:24576
    v_mfma_f32_16x16x32_bf16 v[172:175], v[36:39], a[4:7], v[172:175]
    ds_read_b64_tr_b16 v[134:135], v5 offset:24832
    ds_read_b64_tr_b16 v[136:137], v6 offset:24576
    v_mfma_f32_16x16x32_bf16 v[176:179], v[40:43], a[0:3], v[176:179]
    ds_read_b64_tr_b16 v[138:139], v6 offset:24832
    buffer_load_dwordx4 v241, s[28:31], s54 offen offset:1024 sc1 lds
    v_mfma_f32_16x16x32_bf16 v[180:183], v[40:43], a[4:7], v[180:183]
    ds_read_b64_tr_b16 v[140:141], v7 offset:24576
    v_mfma_f32_16x16x32_bf16 v[184:187], v[44:47], a[0:3], v[184:187]
    ds_read_b64_tr_b16 v[142:143], v7 offset:24832
    buffer_load_dwordx4 v241, s[28:31], s54 offen offset:2048 sc1 lds
    v_mfma_f32_16x16x32_bf16 v[188:191], v[44:47], a[4:7], v[188:191]
    ds_read_b128 v[152:155], v17 offset:2048
    s_waitcnt lgkmcnt(13)
    v_mfma_f32_16x16x32_bf16 v[192:195], v[48:51], v[148:151], v[192:195]
    s_waitcnt vmcnt(15)
    ds_read_b128 a[128:131], v15 offset:32768
    v_mfma_f32_16x16x32_bf16 v[160:163], v[48:51], a[8:11], v[160:163]
    ds_read_b128 a[132:135], v15 offset:34816
    ds_read_b128 a[136:139], v16 offset:32768
    v_mfma_f32_16x16x32_bf16 v[164:167], v[48:51], a[12:15], v[164:167]
    ds_read_b128 a[140:143], v16 offset:34816
    ds_read_b64_tr_b16 v[32:33], v4 offset:28672
    buffer_load_dwordx4 v241, s[28:31], s54 offen offset:3072 sc1 lds
    v_mfma_f32_16x16x32_bf16 v[168:171], v[52:55], a[8:11], v[168:171]
    ds_read_b64_tr_b16 v[34:35], v4 offset:28928
    ds_read_b64_tr_b16 v[36:37], v5 offset:28672
    v_mfma_f32_16x16x32_bf16 v[172:175], v[52:55], a[12:15], v[172:175]
    ds_read_b64_tr_b16 v[38:39], v5 offset:28928
    ds_read_b64_tr_b16 v[40:41], v6 offset:28672
    v_mfma_f32_16x16x32_bf16 v[176:179], v[56:59], a[8:11], v[176:179]
    ds_read_b64_tr_b16 v[42:43], v6 offset:28928
    v_mfma_f32_16x16x32_bf16 v[180:183], v[56:59], a[12:15], v[180:183]
    ds_read_b64_tr_b16 v[44:45], v7 offset:28672
    v_mfma_f32_16x16x32_bf16 v[184:187], v[60:63], a[8:11], v[184:187]
    ds_read_b64_tr_b16 v[46:47], v7 offset:28928
    v_mfma_f32_16x16x32_bf16 v[188:191], v[60:63], a[12:15], v[188:191]
    ds_read_b128 v[144:147], v18 offset:2048
    s_waitcnt vmcnt(8)
    s_barrier
    s_waitcnt lgkmcnt(13)
    v_mfma_f32_16x16x32_bf16 v[192:195], v[128:131], v[152:155], v[192:195]
    ds_read_b128 a[144:147], v15 offset:49152
    v_mfma_f32_16x16x32_bf16 v[160:163], v[128:131], a[16:19], v[160:163]
    ds_read_b128 a[148:151], v15 offset:51200
    ds_read_b128 a[152:155], v16 offset:49152
    v_mfma_f32_16x16x32_bf16 v[164:167], v[128:131], a[20:23], v[164:167]
    ds_read_b128 a[156:159], v16 offset:51200
    ds_read_b64_tr_b16 v[48:49], v4 offset:32768
    s_add_u32 m0, s58, 65536
    s_xor_b32 s55, s3, 128
    buffer_load_dwordx4 v252, s[20:23], s55 offen lds
    v_mfma_f32_16x16x32_bf16 v[168:171], v[132:135], a[16:19], v[168:171]
    ds_read_b64_tr_b16 v[50:51], v4 offset:33024
    ds_read_b64_tr_b16 v[52:53], v5 offset:32768
    v_mfma_f32_16x16x32_bf16 v[172:175], v[132:135], a[20:23], v[172:175]
    ds_read_b64_tr_b16 v[54:55], v5 offset:33024
    ds_read_b64_tr_b16 v[56:57], v6 offset:32768
    v_mfma_f32_16x16x32_bf16 v[176:179], v[136:139], a[16:19], v[176:179]
    ds_read_b64_tr_b16 v[58:59], v6 offset:33024
    buffer_load_dwordx4 v253, s[20:23], s55 offen offset:1024 lds
    v_mfma_f32_16x16x32_bf16 v[180:183], v[136:139], a[20:23], v[180:183]
    ds_read_b64_tr_b16 v[60:61], v7 offset:32768
    v_mfma_f32_16x16x32_bf16 v[184:187], v[140:143], a[16:19], v[184:187]
    ds_read_b64_tr_b16 v[62:63], v7 offset:33024
    buffer_load_dwordx4 v254, s[20:23], s55 offen offset:2048 lds
    v_mfma_f32_16x16x32_bf16 v[188:191], v[140:143], a[20:23], v[188:191]
    ds_read_b128 v[148:151], v17 offset:4096
    s_waitcnt lgkmcnt(13)
    v_mfma_f32_16x16x32_bf16 v[192:195], v[32:35], v[144:147], v[192:195]
    ds_read_b64_tr_b16 v[128:129], v4 offset:36864
    v_mfma_f32_16x16x32_bf16 v[160:163], v[32:35], a[24:27], v[160:163]
    ds_read_b64_tr_b16 v[130:131], v4 offset:37120
    v_mfma_f32_16x16x32_bf16 v[164:167], v[32:35], a[28:31], v[164:167]
    ds_read_b64_tr_b16 v[132:133], v5 offset:36864
    buffer_load_dwordx4 v255, s[20:23], s55 offen offset:3072 lds
    v_mfma_f32_16x16x32_bf16 v[168:171], v[36:39], a[24:27], v[168:171]
    ds_read_b64_tr_b16 v[134:135], v5 offset:37120
    v_mfma_f32_16x16x32_bf16 v[172:175], v[36:39], a[28:31], v[172:175]
    ds_read_b64_tr_b16 v[136:137], v6 offset:36864
    v_mfma_f32_16x16x32_bf16 v[176:179], v[40:43], a[24:27], v[176:179]
    ds_read_b64_tr_b16 v[138:139], v6 offset:37120
    s_add_u32 m0, s58, 81920
    s_xor_b32 s55, s3, 128
    buffer_load_dwordx4 v252, s[24:27], s55 offen lds
    v_mfma_f32_16x16x32_bf16 v[180:183], v[40:43], a[28:31], v[180:183]
    ds_read_b64_tr_b16 v[140:141], v7 offset:36864
    v_mfma_f32_16x16x32_bf16 v[184:187], v[44:47], a[24:27], v[184:187]
    ds_read_b64_tr_b16 v[142:143], v7 offset:37120
    buffer_load_dwordx4 v253, s[24:27], s55 offen offset:1024 lds
    v_mfma_f32_16x16x32_bf16 v[188:191], v[44:47], a[28:31], v[188:191]
    ds_read_b128 v[152:155], v18 offset:4096
    s_waitcnt lgkmcnt(9)
    v_mfma_f32_16x16x32_bf16 v[192:195], v[48:51], v[148:151], v[192:195]
    ds_read_b64_tr_b16 v[32:33], v4 offset:40960
    v_mfma_f32_16x16x32_bf16 v[160:163], v[48:51], a[32:35], v[160:163]
    ds_read_b64_tr_b16 v[34:35], v4 offset:41216
    v_mfma_f32_16x16x32_bf16 v[164:167], v[48:51], a[36:39], v[164:167]
    ds_read_b64_tr_b16 v[36:37], v5 offset:40960
    buffer_load_dwordx4 v254, s[24:27], s55 offen offset:2048 lds
    v_mfma_f32_16x16x32_bf16 v[168:171], v[52:55], a[32:35], v[168:171]
    ds_read_b64_tr_b16 v[38:39], v5 offset:41216
    v_mfma_f32_16x16x32_bf16 v[172:175], v[52:55], a[36:39], v[172:175]
    ds_read_b64_tr_b16 v[40:41], v6 offset:40960
    v_mfma_f32_16x16x32_bf16 v[176:179], v[56:59], a[32:35], v[176:179]
    ds_read_b64_tr_b16 v[42:43], v6 offset:41216
    buffer_load_dwordx4 v255, s[24:27], s55 offen offset:3072 lds
    v_mfma_f32_16x16x32_bf16 v[180:183], v[56:59], a[36:39], v[180:183]
    ds_read_b64_tr_b16 v[44:45], v7 offset:40960
    v_mfma_f32_16x16x32_bf16 v[184:187], v[60:63], a[32:35], v[184:187]
    ds_read_b64_tr_b16 v[46:47], v7 offset:41216
    s_add_u32 m0, s58, 98304
    s_xor_b32 s55, s3, 256
    buffer_load_dwordx4 v252, s[20:23], s55 offen lds
    v_mfma_f32_16x16x32_bf16 v[188:191], v[60:63], a[36:39], v[188:191]
    ds_read_b128 v[144:147], v17 offset:6144
    s_waitcnt lgkmcnt(9)
    v_mfma_f32_16x16x32_bf16 v[192:195], v[128:131], v[152:155], v[192:195]
    ds_read_b64_tr_b16 v[48:49], v4 offset:45056
    v_mfma_f32_16x16x32_bf16 v[160:163], v[128:131], a[40:43], v[160:163]
    ds_read_b64_tr_b16 v[50:51], v4 offset:45312
    v_mfma_f32_16x16x32_bf16 v[164:167], v[128:131], a[44:47], v[164:167]
    ds_read_b64_tr_b16 v[52:53], v5 offset:45056
    buffer_load_dwordx4 v253, s[20:23], s55 offen offset:1024 lds
    v_mfma_f32_16x16x32_bf16 v[168:171], v[132:135], a[40:43], v[168:171]
    ds_read_b64_tr_b16 v[54:55], v5 offset:45312
    v_mfma_f32_16x16x32_bf16 v[172:175], v[132:135], a[44:47], v[172:175]
    ds_read_b64_tr_b16 v[56:57], v6 offset:45056
    v_mfma_f32_16x16x32_bf16 v[176:179], v[136:139], a[40:43], v[176:179]
    ds_read_b64_tr_b16 v[58:59], v6 offset:45312
    buffer_load_dwordx4 v254, s[20:23], s55 offen offset:2048 lds
    v_mfma_f32_16x16x32_bf16 v[180:183], v[136:139], a[44:47], v[180:183]
    ds_read_b64_tr_b16 v[60:61], v7 offset:45056
    v_mfma_f32_16x16x32_bf16 v[184:187], v[140:143], a[40:43], v[184:187]
    ds_read_b64_tr_b16 v[62:63], v7 offset:45312
    buffer_load_dwordx4 v255, s[20:23], s55 offen offset:3072 lds
    v_mfma_f32_16x16x32_bf16 v[188:191], v[140:143], a[44:47], v[188:191]
    ds_read_b128 v[148:151], v18 offset:6144
    s_waitcnt vmcnt(16)
    s_barrier
    s_waitcnt lgkmcnt(9)
    v_mfma_f32_16x16x32_bf16 v[192:195], v[32:35], v[144:147], v[192:195]
    ds_read_b64_tr_b16 v[128:129], v4 offset:49152
    v_mfma_f32_16x16x32_bf16 v[160:163], v[32:35], a[48:51], v[160:163]
    ds_read_b64_tr_b16 v[130:131], v4 offset:49408
    v_mfma_f32_16x16x32_bf16 v[164:167], v[32:35], a[52:55], v[164:167]
    ds_read_b64_tr_b16 v[132:133], v5 offset:49152
    s_add_u32 m0, s58, 16384
    s_bfe_u32 s54, s1, 524312
    s_lshl_b32 s54, s54, 7
    s_lshl_b32 s54, s54, 6
    s_add_u32 s54, s54, s63
    buffer_load_dwordx4 v241, s[28:31], s54 offen sc1 lds
    v_mfma_f32_16x16x32_bf16 v[168:171], v[36:39], a[48:51], v[168:171]
    ds_read_b64_tr_b16 v[134:135], v5 offset:49408
    v_mfma_f32_16x16x32_bf16 v[172:175], v[36:39], a[52:55], v[172:175]
    ds_read_b64_tr_b16 v[136:137], v6 offset:49152
    v_mfma_f32_16x16x32_bf16 v[176:179], v[40:43], a[48:51], v[176:179]
    ds_read_b64_tr_b16 v[138:139], v6 offset:49408
    buffer_load_dwordx4 v241, s[28:31], s54 offen offset:1024 sc1 lds
    v_mfma_f32_16x16x32_bf16 v[180:183], v[40:43], a[52:55], v[180:183]
    ds_read_b64_tr_b16 v[140:141], v7 offset:49152
    v_mfma_f32_16x16x32_bf16 v[184:187], v[44:47], a[48:51], v[184:187]
    ds_read_b64_tr_b16 v[142:143], v7 offset:49408
    buffer_load_dwordx4 v241, s[28:31], s54 offen offset:2048 sc1 lds
    v_mfma_f32_16x16x32_bf16 v[188:191], v[44:47], a[52:55], v[188:191]
    ds_read_b128 v[152:155], v17 offset:8192
    s_waitcnt lgkmcnt(9)
    v_mfma_f32_16x16x32_bf16 v[192:195], v[48:51], v[148:151], v[192:195]
    s_waitcnt vmcnt(11)
    ds_read_b128 a[160:163], v15 offset:16384
    v_mfma_f32_16x16x32_bf16 v[160:163], v[48:51], a[56:59], v[160:163]
    ds_read_b128 a[164:167], v15 offset:18432
    ds_read_b128 a[168:171], v16 offset:16384
    v_mfma_f32_16x16x32_bf16 v[164:167], v[48:51], a[60:63], v[164:167]
    ds_read_b128 a[172:175], v16 offset:18432
    ds_read_b64_tr_b16 v[32:33], v4 offset:53248
    buffer_load_dwordx4 v241, s[28:31], s54 offen offset:3072 sc1 lds
    v_mfma_f32_16x16x32_bf16 v[168:171], v[52:55], a[56:59], v[168:171]
    ds_read_b64_tr_b16 v[34:35], v4 offset:53504
    ds_read_b64_tr_b16 v[36:37], v5 offset:53248
    v_mfma_f32_16x16x32_bf16 v[172:175], v[52:55], a[60:63], v[172:175]
    ds_read_b64_tr_b16 v[38:39], v5 offset:53504
    ds_read_b64_tr_b16 v[40:41], v6 offset:53248
    v_mfma_f32_16x16x32_bf16 v[176:179], v[56:59], a[56:59], v[176:179]
    ds_read_b64_tr_b16 v[42:43], v6 offset:53504
    v_mfma_f32_16x16x32_bf16 v[180:183], v[56:59], a[60:63], v[180:183]
    ds_read_b64_tr_b16 v[44:45], v7 offset:53248
    v_mfma_f32_16x16x32_bf16 v[184:187], v[60:63], a[56:59], v[184:187]
    ds_read_b64_tr_b16 v[46:47], v7 offset:53504
    v_mfma_f32_16x16x32_bf16 v[188:191], v[60:63], a[60:63], v[188:191]
    ds_read_b128 v[144:147], v18 offset:8192
    s_waitcnt lgkmcnt(13)
    v_mfma_f32_16x16x32_bf16 v[192:195], v[128:131], v[152:155], v[192:195]
    s_waitcnt vmcnt(8)
    ds_read_b128 a[176:179], v15 offset:32768
    v_mfma_f32_16x16x32_bf16 v[160:163], v[128:131], a[64:67], v[160:163]
    ds_read_b128 a[180:183], v15 offset:34816
    ds_read_b128 a[184:187], v16 offset:32768
    v_mfma_f32_16x16x32_bf16 v[164:167], v[128:131], a[68:71], v[164:167]
    ds_read_b128 a[188:191], v16 offset:34816
    ds_read_b64_tr_b16 v[48:49], v4 offset:57344
    v_mfma_f32_16x16x32_bf16 v[168:171], v[132:135], a[64:67], v[168:171]
    ds_read_b64_tr_b16 v[50:51], v4 offset:57600
    ds_read_b64_tr_b16 v[52:53], v5 offset:57344
    v_mfma_f32_16x16x32_bf16 v[172:175], v[132:135], a[68:71], v[172:175]
    ds_read_b64_tr_b16 v[54:55], v5 offset:57600
    ds_read_b64_tr_b16 v[56:57], v6 offset:57344
    v_mfma_f32_16x16x32_bf16 v[176:179], v[136:139], a[64:67], v[176:179]
    ds_read_b64_tr_b16 v[58:59], v6 offset:57600
    v_mfma_f32_16x16x32_bf16 v[180:183], v[136:139], a[68:71], v[180:183]
    ds_read_b64_tr_b16 v[60:61], v7 offset:57344
    v_mfma_f32_16x16x32_bf16 v[184:187], v[140:143], a[64:67], v[184:187]
    ds_read_b64_tr_b16 v[62:63], v7 offset:57600
    v_mfma_f32_16x16x32_bf16 v[188:191], v[140:143], a[68:71], v[188:191]
    ds_read_b128 v[148:151], v17 offset:10240
    s_waitcnt lgkmcnt(13)
    v_mfma_f32_16x16x32_bf16 v[192:195], v[32:35], v[144:147], v[192:195]
    s_waitcnt vmcnt(4)
    ds_read_b128 a[192:195], v15 offset:49152
    v_mfma_f32_16x16x32_bf16 v[160:163], v[32:35], a[72:75], v[160:163]
    ds_read_b128 a[196:199], v15 offset:51200
    ds_read_b128 a[200:203], v16 offset:49152
    v_mfma_f32_16x16x32_bf16 v[164:167], v[32:35], a[76:79], v[164:167]
    ds_read_b128 a[204:207], v16 offset:51200
    ds_read_b64_tr_b16 v[128:129], v4 offset:61440
    s_add_u32 m0, s58, 65536
    s_xor_b32 s55, s3, 256
    buffer_load_dwordx4 v252, s[24:27], s55 offen lds
    v_mfma_f32_16x16x32_bf16 v[168:171], v[36:39], a[72:75], v[168:171]
    ds_read_b64_tr_b16 v[130:131], v4 offset:61696
    ds_read_b64_tr_b16 v[132:133], v5 offset:61440
    v_mfma_f32_16x16x32_bf16 v[172:175], v[36:39], a[76:79], v[172:175]
    ds_read_b64_tr_b16 v[134:135], v5 offset:61696
    ds_read_b64_tr_b16 v[136:137], v6 offset:61440
    v_mfma_f32_16x16x32_bf16 v[176:179], v[40:43], a[72:75], v[176:179]
    ds_read_b64_tr_b16 v[138:139], v6 offset:61696
    buffer_load_dwordx4 v253, s[24:27], s55 offen offset:1024 lds
    v_mfma_f32_16x16x32_bf16 v[180:183], v[40:43], a[76:79], v[180:183]
    ds_read_b64_tr_b16 v[140:141], v7 offset:61440
    v_mfma_f32_16x16x32_bf16 v[184:187], v[44:47], a[72:75], v[184:187]
    ds_read_b64_tr_b16 v[142:143], v7 offset:61696
    buffer_load_dwordx4 v254, s[24:27], s55 offen offset:2048 lds
    v_mfma_f32_16x16x32_bf16 v[188:191], v[44:47], a[76:79], v[188:191]
    ds_read_b128 v[152:155], v18 offset:10240
    s_barrier
    s_waitcnt lgkmcnt(13)
    v_mfma_f32_16x16x32_bf16 v[192:195], v[48:51], v[148:151], v[192:195]
    ds_read_b64_tr_b16 v[32:33], v4 offset:0
    v_mfma_f32_16x16x32_bf16 v[160:163], v[48:51], a[80:83], v[160:163]
    ds_read_b64_tr_b16 v[34:35], v4 offset:256
    v_mfma_f32_16x16x32_bf16 v[164:167], v[48:51], a[84:87], v[164:167]
    ds_read_b64_tr_b16 v[36:37], v5 offset:0
    buffer_load_dwordx4 v255, s[24:27], s55 offen offset:3072 lds
    v_mfma_f32_16x16x32_bf16 v[168:171], v[52:55], a[80:83], v[168:171]
    ds_read_b64_tr_b16 v[38:39], v5 offset:256
    v_mfma_f32_16x16x32_bf16 v[172:175], v[52:55], a[84:87], v[172:175]
    ds_read_b64_tr_b16 v[40:41], v6 offset:0
    v_mfma_f32_16x16x32_bf16 v[176:179], v[56:59], a[80:83], v[176:179]
    ds_read_b64_tr_b16 v[42:43], v6 offset:256
    s_add_u32 m0, s58, 32768
    s_xor_b32 s54, s3, 128
    s_lshl_b32 s54, s54, 6
    s_add_u32 s54, s54, s63
    buffer_load_dwordx4 v241, s[28:31], s54 offen sc1 lds
    v_mfma_f32_16x16x32_bf16 v[180:183], v[56:59], a[84:87], v[180:183]
    ds_read_b64_tr_b16 v[44:45], v7 offset:0
    v_mfma_f32_16x16x32_bf16 v[184:187], v[60:63], a[80:83], v[184:187]
    ds_read_b64_tr_b16 v[46:47], v7 offset:256
    buffer_load_dwordx4 v241, s[28:31], s54 offen offset:1024 sc1 lds
    v_mfma_f32_16x16x32_bf16 v[188:191], v[60:63], a[84:87], v[188:191]
    ds_read_b128 v[144:147], v17 offset:12288
    s_waitcnt lgkmcnt(9)
    v_mfma_f32_16x16x32_bf16 v[192:195], v[128:131], v[152:155], v[192:195]
    ds_read_b64_tr_b16 v[48:49], v4 offset:4096
    v_mfma_f32_16x16x32_bf16 v[160:163], v[128:131], a[88:91], v[160:163]
    ds_read_b64_tr_b16 v[50:51], v4 offset:4352
    v_mfma_f32_16x16x32_bf16 v[164:167], v[128:131], a[92:95], v[164:167]
    ds_read_b64_tr_b16 v[52:53], v5 offset:4096
    buffer_load_dwordx4 v241, s[28:31], s54 offen offset:2048 sc1 lds
    v_mfma_f32_16x16x32_bf16 v[168:171], v[132:135], a[88:91], v[168:171]
    ds_read_b64_tr_b16 v[54:55], v5 offset:4352
    v_mfma_f32_16x16x32_bf16 v[172:175], v[132:135], a[92:95], v[172:175]
    ds_read_b64_tr_b16 v[56:57], v6 offset:4096
    v_mfma_f32_16x16x32_bf16 v[176:179], v[136:139], a[88:91], v[176:179]
    ds_read_b64_tr_b16 v[58:59], v6 offset:4352
    buffer_load_dwordx4 v241, s[28:31], s54 offen offset:3072 sc1 lds
    v_mfma_f32_16x16x32_bf16 v[180:183], v[136:139], a[92:95], v[180:183]
    ds_read_b64_tr_b16 v[60:61], v7 offset:4096
    v_mfma_f32_16x16x32_bf16 v[184:187], v[140:143], a[88:91], v[184:187]
    ds_read_b64_tr_b16 v[62:63], v7 offset:4352
    s_add_u32 m0, s58, 81920
    s_xor_b32 s55, s3, 384
    buffer_load_dwordx4 v252, s[20:23], s55 offen lds
    v_mfma_f32_16x16x32_bf16 v[188:191], v[140:143], a[92:95], v[188:191]
    ds_read_b128 v[148:151], v18 offset:12288
    s_waitcnt lgkmcnt(9)
    v_mfma_f32_16x16x32_bf16 v[192:195], v[32:35], v[144:147], v[192:195]
    ds_read_b64_tr_b16 v[128:129], v4 offset:8192
    v_mfma_f32_16x16x32_bf16 v[160:163], v[32:35], a[96:99], v[160:163]
    ds_read_b64_tr_b16 v[130:131], v4 offset:8448
    v_mfma_f32_16x16x32_bf16 v[164:167], v[32:35], a[100:103], v[164:167]
    ds_read_b64_tr_b16 v[132:133], v5 offset:8192
    buffer_load_dwordx4 v253, s[20:23], s55 offen offset:1024 lds
    v_mfma_f32_16x16x32_bf16 v[168:171], v[36:39], a[96:99], v[168:171]
    ds_read_b64_tr_b16 v[134:135], v5 offset:8448
    v_mfma_f32_16x16x32_bf16 v[172:175], v[36:39], a[100:103], v[172:175]
    ds_read_b64_tr_b16 v[136:137], v6 offset:8192
    v_mfma_f32_16x16x32_bf16 v[176:179], v[40:43], a[96:99], v[176:179]
    ds_read_b64_tr_b16 v[138:139], v6 offset:8448
    buffer_load_dwordx4 v254, s[20:23], s55 offen offset:2048 lds
    v_mfma_f32_16x16x32_bf16 v[180:183], v[40:43], a[100:103], v[180:183]
    ds_read_b64_tr_b16 v[140:141], v7 offset:8192
    v_mfma_f32_16x16x32_bf16 v[184:187], v[44:47], a[96:99], v[184:187]
    ds_read_b64_tr_b16 v[142:143], v7 offset:8448
    buffer_load_dwordx4 v255, s[20:23], s55 offen offset:3072 lds
    v_mfma_f32_16x16x32_bf16 v[188:191], v[44:47], a[100:103], v[188:191]
    ds_read_b128 v[152:155], v17 offset:14336
    s_waitcnt lgkmcnt(9)
    v_mfma_f32_16x16x32_bf16 v[192:195], v[48:51], v[148:151], v[192:195]
    ds_read_b64_tr_b16 v[32:33], v4 offset:12288
    v_mfma_f32_16x16x32_bf16 v[160:163], v[48:51], a[104:107], v[160:163]
    ds_read_b64_tr_b16 v[34:35], v4 offset:12544
    v_mfma_f32_16x16x32_bf16 v[164:167], v[48:51], a[108:111], v[164:167]
    ds_read_b64_tr_b16 v[36:37], v5 offset:12288
    s_add_u32 m0, s58, 98304
    s_xor_b32 s55, s3, 384
    buffer_load_dwordx4 v252, s[24:27], s55 offen lds
    v_mfma_f32_16x16x32_bf16 v[168:171], v[52:55], a[104:107], v[168:171]
    ds_read_b64_tr_b16 v[38:39], v5 offset:12544
    v_mfma_f32_16x16x32_bf16 v[172:175], v[52:55], a[108:111], v[172:175]
    ds_read_b64_tr_b16 v[40:41], v6 offset:12288
    v_mfma_f32_16x16x32_bf16 v[176:179], v[56:59], a[104:107], v[176:179]
    ds_read_b64_tr_b16 v[42:43], v6 offset:12544
    buffer_load_dwordx4 v253, s[24:27], s55 offen offset:1024 lds
    v_mfma_f32_16x16x32_bf16 v[180:183], v[56:59], a[108:111], v[180:183]
    ds_read_b64_tr_b16 v[44:45], v7 offset:12288
    v_mfma_f32_16x16x32_bf16 v[184:187], v[60:63], a[104:107], v[184:187]
    ds_read_b64_tr_b16 v[46:47], v7 offset:12544
    buffer_load_dwordx4 v254, s[24:27], s55 offen offset:2048 lds
    v_mfma_f32_16x16x32_bf16 v[188:191], v[60:63], a[108:111], v[188:191]
    ds_read_b128 v[144:147], v18 offset:14336
    s_waitcnt vmcnt(15)
    s_barrier
    s_waitcnt lgkmcnt(9)
    v_mfma_f32_16x16x32_bf16 v[192:195], v[128:131], v[152:155], v[192:195]
    s_waitcnt vmcnt(11)
    ds_read_b128 a[208:211], v15 offset:16384
    v_mfma_f32_16x16x32_bf16 v[160:163], v[128:131], a[112:115], v[160:163]
    ds_read_b128 a[212:215], v15 offset:18432
    ds_read_b128 a[216:219], v16 offset:16384
    v_mfma_f32_16x16x32_bf16 v[164:167], v[128:131], a[116:119], v[164:167]
    ds_read_b128 a[220:223], v16 offset:18432
    ds_read_b64_tr_b16 v[48:49], v4 offset:16384
    buffer_load_dwordx4 v255, s[24:27], s55 offen offset:3072 lds
    v_mfma_f32_16x16x32_bf16 v[168:171], v[132:135], a[112:115], v[168:171]
    ds_read_b64_tr_b16 v[50:51], v4 offset:16640
    ds_read_b64_tr_b16 v[52:53], v5 offset:16384
    v_mfma_f32_16x16x32_bf16 v[172:175], v[132:135], a[116:119], v[172:175]
    ds_read_b64_tr_b16 v[54:55], v5 offset:16640
    ds_read_b64_tr_b16 v[56:57], v6 offset:16384
    v_mfma_f32_16x16x32_bf16 v[176:179], v[136:139], a[112:115], v[176:179]
    ds_read_b64_tr_b16 v[58:59], v6 offset:16640
    s_add_u32 m0, s58, 49152
    s_xor_b32 s54, s3, 256
    s_lshl_b32 s54, s54, 6
    s_add_u32 s54, s54, s63
    buffer_load_dwordx4 v241, s[28:31], s54 offen sc1 lds
    v_mfma_f32_16x16x32_bf16 v[180:183], v[136:139], a[116:119], v[180:183]
    ds_read_b64_tr_b16 v[60:61], v7 offset:16384
    v_mfma_f32_16x16x32_bf16 v[184:187], v[140:143], a[112:115], v[184:187]
    ds_read_b64_tr_b16 v[62:63], v7 offset:16640
    buffer_load_dwordx4 v241, s[28:31], s54 offen offset:1024 sc1 lds
    v_mfma_f32_16x16x32_bf16 v[188:191], v[140:143], a[116:119], v[188:191]
    ds_read_b128 v[148:151], v17 offset:16384
    s_waitcnt lgkmcnt(13)
    v_mfma_f32_16x16x32_bf16 v[192:195], v[32:35], v[144:147], v[192:195]
    ds_read_b64_tr_b16 v[128:129], v4 offset:20480
    v_mfma_f32_16x16x32_bf16 v[160:163], v[32:35], a[120:123], v[160:163]
    ds_read_b64_tr_b16 v[130:131], v4 offset:20736
    v_mfma_f32_16x16x32_bf16 v[164:167], v[32:35], a[124:127], v[164:167]
    ds_read_b64_tr_b16 v[132:133], v5 offset:20480
    buffer_load_dwordx4 v241, s[28:31], s54 offen offset:2048 sc1 lds
    v_mfma_f32_16x16x32_bf16 v[168:171], v[36:39], a[120:123], v[168:171]
    ds_read_b64_tr_b16 v[134:135], v5 offset:20736
    v_mfma_f32_16x16x32_bf16 v[172:175], v[36:39], a[124:127], v[172:175]
    ds_read_b64_tr_b16 v[136:137], v6 offset:20480
    v_mfma_f32_16x16x32_bf16 v[176:179], v[40:43], a[120:123], v[176:179]
    ds_read_b64_tr_b16 v[138:139], v6 offset:20736
    buffer_load_dwordx4 v241, s[28:31], s54 offen offset:3072 sc1 lds
    v_mfma_f32_16x16x32_bf16 v[180:183], v[40:43], a[124:127], v[180:183]
    ds_read_b64_tr_b16 v[140:141], v7 offset:20480
    v_mfma_f32_16x16x32_bf16 v[184:187], v[44:47], a[120:123], v[184:187]
    ds_read_b64_tr_b16 v[142:143], v7 offset:20736
    v_mfma_f32_16x16x32_bf16 v[188:191], v[44:47], a[124:127], v[188:191]
    ds_read_b128 v[152:155], v18 offset:16384
    s_waitcnt lgkmcnt(9)
    v_mfma_f32_16x16x32_bf16 v[192:195], v[48:51], v[148:151], v[192:195]
    s_waitcnt vmcnt(8)
    ds_read_b128 a[224:227], v15 offset:32768
    v_mfma_f32_16x16x32_bf16 v[160:163], v[48:51], a[128:131], v[160:163]
    ds_read_b128 a[228:231], v15 offset:34816
    ds_read_b128 a[232:235], v16 offset:32768
    v_mfma_f32_16x16x32_bf16 v[164:167], v[48:51], a[132:135], v[164:167]
    ds_read_b128 a[236:239], v16 offset:34816
    ds_read_b64_tr_b16 v[32:33], v4 offset:24576
    s_add_u32 m0, s58, 65536
    s_mov_b32 s55, 1024
    buffer_load_dwordx4 v252, s[20:23], s55 offen lds
    v_mfma_f32_16x16x32_bf16 v[168:171], v[52:55], a[128:131], v[168:171]
    ds_read_b64_tr_b16 v[34:35], v4 offset:24832
    ds_read_b64_tr_b16 v[36:37], v5 offset:24576
    v_mfma_f32_16x16x32_bf16 v[172:175], v[52:55], a[132:135], v[172:175]
    ds_read_b64_tr_b16 v[38:39], v5 offset:24832
    ds_read_b64_tr_b16 v[40:41], v6 offset:24576
    v_mfma_f32_16x16x32_bf16 v[176:179], v[56:59], a[128:131], v[176:179]
    ds_read_b64_tr_b16 v[42:43], v6 offset:24832
    buffer_load_dwordx4 v253, s[20:23], s55 offen offset:1024 lds
    v_mfma_f32_16x16x32_bf16 v[180:183], v[56:59], a[132:135], v[180:183]
    ds_read_b64_tr_b16 v[44:45], v7 offset:24576
    v_mfma_f32_16x16x32_bf16 v[184:187], v[60:63], a[128:131], v[184:187]
    ds_read_b64_tr_b16 v[46:47], v7 offset:24832
    buffer_load_dwordx4 v254, s[20:23], s55 offen offset:2048 lds
    v_mfma_f32_16x16x32_bf16 v[188:191], v[60:63], a[132:135], v[188:191]
    ds_read_b128 v[144:147], v17 offset:18432
    s_waitcnt lgkmcnt(13)
    v_mfma_f32_16x16x32_bf16 v[192:195], v[128:131], v[152:155], v[192:195]
    ds_read_b64_tr_b16 v[48:49], v4 offset:28672
    v_mfma_f32_16x16x32_bf16 v[160:163], v[128:131], a[136:139], v[160:163]
    ds_read_b64_tr_b16 v[50:51], v4 offset:28928
    v_mfma_f32_16x16x32_bf16 v[164:167], v[128:131], a[140:143], v[164:167]
    ds_read_b64_tr_b16 v[52:53], v5 offset:28672
    buffer_load_dwordx4 v255, s[20:23], s55 offen offset:3072 lds
    v_mfma_f32_16x16x32_bf16 v[168:171], v[132:135], a[136:139], v[168:171]
    ds_read_b64_tr_b16 v[54:55], v5 offset:28928
    v_mfma_f32_16x16x32_bf16 v[172:175], v[132:135], a[140:143], v[172:175]
    ds_read_b64_tr_b16 v[56:57], v6 offset:28672
    v_mfma_f32_16x16x32_bf16 v[176:179], v[136:139], a[136:139], v[176:179]
    ds_read_b64_tr_b16 v[58:59], v6 offset:28928
    v_mfma_f32_16x16x32_bf16 v[180:183], v[136:139], a[140:143], v[180:183]
    ds_read_b64_tr_b16 v[60:61], v7 offset:28672
    v_mfma_f32_16x16x32_bf16 v[184:187], v[140:143], a[136:139], v[184:187]
    ds_read_b64_tr_b16 v[62:63], v7 offset:28928
    v_mfma_f32_16x16x32_bf16 v[188:191], v[140:143], a[140:143], v[188:191]
    ds_read_b128 v[148:151], v18 offset:18432
    s_barrier
    s_waitcnt lgkmcnt(9)
    v_mfma_f32_16x16x32_bf16 v[192:195], v[32:35], v[144:147], v[192:195]
    s_waitcnt vmcnt(8)
    ds_read_b128 a[240:243], v15 offset:49152
    v_mfma_f32_16x16x32_bf16 v[160:163], v[32:35], a[144:147], v[160:163]
    ds_read_b128 a[244:247], v15 offset:51200
    ds_read_b128 a[248:251], v16 offset:49152
    v_mfma_f32_16x16x32_bf16 v[164:167], v[32:35], a[148:151], v[164:167]
    ds_read_b128 a[252:255], v16 offset:51200
    ds_read_b64_tr_b16 v[128:129], v4 offset:32768
    s_add_u32 m0, s58, 0
    s_xor_b32 s54, s3, 384
    s_lshl_b32 s54, s54, 6
    s_add_u32 s54, s54, s63
    buffer_load_dwordx4 v241, s[28:31], s54 offen sc1 lds
    v_mfma_f32_16x16x32_bf16 v[168:171], v[36:39], a[144:147], v[168:171]
    ds_read_b64_tr_b16 v[130:131], v4 offset:33024
    ds_read_b64_tr_b16 v[132:133], v5 offset:32768
    v_mfma_f32_16x16x32_bf16 v[172:175], v[36:39], a[148:151], v[172:175]
    ds_read_b64_tr_b16 v[134:135], v5 offset:33024
    ds_read_b64_tr_b16 v[136:137], v6 offset:32768
    v_mfma_f32_16x16x32_bf16 v[176:179], v[40:43], a[144:147], v[176:179]
    ds_read_b64_tr_b16 v[138:139], v6 offset:33024
    buffer_load_dwordx4 v241, s[28:31], s54 offen offset:1024 sc1 lds
    v_mfma_f32_16x16x32_bf16 v[180:183], v[40:43], a[148:151], v[180:183]
    ds_read_b64_tr_b16 v[140:141], v7 offset:32768
    v_mfma_f32_16x16x32_bf16 v[184:187], v[44:47], a[144:147], v[184:187]
    ds_read_b64_tr_b16 v[142:143], v7 offset:33024
    buffer_load_dwordx4 v241, s[28:31], s54 offen offset:2048 sc1 lds
    v_mfma_f32_16x16x32_bf16 v[188:191], v[44:47], a[148:151], v[188:191]
    ds_read_b128 v[152:155], v17 offset:20480
    s_waitcnt lgkmcnt(13)
    v_mfma_f32_16x16x32_bf16 v[192:195], v[48:51], v[148:151], v[192:195]
    ds_read_b64_tr_b16 v[32:33], v4 offset:36864
    v_mfma_f32_16x16x32_bf16 v[160:163], v[48:51], a[152:155], v[160:163]
    ds_read_b64_tr_b16 v[34:35], v4 offset:37120
    v_mfma_f32_16x16x32_bf16 v[164:167], v[48:51], a[156:159], v[164:167]
    ds_read_b64_tr_b16 v[36:37], v5 offset:36864
    buffer_load_dwordx4 v241, s[28:31], s54 offen offset:3072 sc1 lds
    v_mfma_f32_16x16x32_bf16 v[168:171], v[52:55], a[152:155], v[168:171]
    ds_read_b64_tr_b16 v[38:39], v5 offset:37120
    v_mfma_f32_16x16x32_bf16 v[172:175], v[52:55], a[156:159], v[172:175]
    ds_read_b64_tr_b16 v[40:41], v6 offset:36864
    v_mfma_f32_16x16x32_bf16 v[176:179], v[56:59], a[152:155], v[176:179]
    ds_read_b64_tr_b16 v[42:43], v6 offset:37120
    s_add_u32 m0, s58, 81920
    s_mov_b32 s55, 1024
    buffer_load_dwordx4 v252, s[24:27], s55 offen lds
    v_mfma_f32_16x16x32_bf16 v[180:183], v[56:59], a[156:159], v[180:183]
    ds_read_b64_tr_b16 v[44:45], v7 offset:36864
    v_mfma_f32_16x16x32_bf16 v[184:187], v[60:63], a[152:155], v[184:187]
    ds_read_b64_tr_b16 v[46:47], v7 offset:37120
    buffer_load_dwordx4 v253, s[24:27], s55 offen offset:1024 lds
    v_mfma_f32_16x16x32_bf16 v[188:191], v[60:63], a[156:159], v[188:191]
    ds_read_b128 v[144:147], v18 offset:20480
    s_waitcnt lgkmcnt(9)
    v_mfma_f32_16x16x32_bf16 v[192:195], v[128:131], v[152:155], v[192:195]
    ds_read_b64_tr_b16 v[48:49], v4 offset:40960
    v_mfma_f32_16x16x32_bf16 v[160:163], v[128:131], a[160:163], v[160:163]
    ds_read_b64_tr_b16 v[50:51], v4 offset:41216
    v_mfma_f32_16x16x32_bf16 v[164:167], v[128:131], a[164:167], v[164:167]
    ds_read_b64_tr_b16 v[52:53], v5 offset:40960
    buffer_load_dwordx4 v254, s[24:27], s55 offen offset:2048 lds
    v_mfma_f32_16x16x32_bf16 v[168:171], v[132:135], a[160:163], v[168:171]
    ds_read_b64_tr_b16 v[54:55], v5 offset:41216
    v_mfma_f32_16x16x32_bf16 v[172:175], v[132:135], a[164:167], v[172:175]
    ds_read_b64_tr_b16 v[56:57], v6 offset:40960
    v_mfma_f32_16x16x32_bf16 v[176:179], v[136:139], a[160:163], v[176:179]
    ds_read_b64_tr_b16 v[58:59], v6 offset:41216
    buffer_load_dwordx4 v255, s[24:27], s55 offen offset:3072 lds
    v_mfma_f32_16x16x32_bf16 v[180:183], v[136:139], a[164:167], v[180:183]
    ds_read_b64_tr_b16 v[60:61], v7 offset:40960
    v_mfma_f32_16x16x32_bf16 v[184:187], v[140:143], a[160:163], v[184:187]
    ds_read_b64_tr_b16 v[62:63], v7 offset:41216
    v_mfma_f32_16x16x32_bf16 v[188:191], v[140:143], a[164:167], v[188:191]
    ds_read_b128 v[148:151], v17 offset:22528
    s_waitcnt lgkmcnt(9)
    v_mfma_f32_16x16x32_bf16 v[192:195], v[32:35], v[144:147], v[192:195]
    s_waitcnt vmcnt(8)
    ds_read_b128 v[196:199], v15 offset:16384
    v_mfma_f32_16x16x32_bf16 v[160:163], v[32:35], a[168:171], v[160:163]
    ds_read_b128 v[200:203], v15 offset:18432
    ds_read_b128 v[204:207], v16 offset:16384
    v_mfma_f32_16x16x32_bf16 v[164:167], v[32:35], a[172:175], v[164:167]
    ds_read_b128 v[208:211], v16 offset:18432
    ds_read_b64_tr_b16 v[128:129], v4 offset:45056
    v_mfma_f32_16x16x32_bf16 v[168:171], v[36:39], a[168:171], v[168:171]
    ds_read_b64_tr_b16 v[130:131], v4 offset:45312
    ds_read_b64_tr_b16 v[132:133], v5 offset:45056
    v_mfma_f32_16x16x32_bf16 v[172:175], v[36:39], a[172:175], v[172:175]
    ds_read_b64_tr_b16 v[134:135], v5 offset:45312
    ds_read_b64_tr_b16 v[136:137], v6 offset:45056
    v_mfma_f32_16x16x32_bf16 v[176:179], v[40:43], a[168:171], v[176:179]
    ds_read_b64_tr_b16 v[138:139], v6 offset:45312
    v_mfma_f32_16x16x32_bf16 v[180:183], v[40:43], a[172:175], v[180:183]
    ds_read_b64_tr_b16 v[140:141], v7 offset:45056
    v_mfma_f32_16x16x32_bf16 v[184:187], v[44:47], a[168:171], v[184:187]
    ds_read_b64_tr_b16 v[142:143], v7 offset:45312
    v_mfma_f32_16x16x32_bf16 v[188:191], v[44:47], a[172:175], v[188:191]
    ds_read_b128 v[152:155], v18 offset:22528
    s_barrier
    s_waitcnt lgkmcnt(13)
    v_mfma_f32_16x16x32_bf16 v[192:195], v[48:51], v[148:151], v[192:195]
    ds_read_b64_tr_b16 v[32:33], v4 offset:49152
    v_mfma_f32_16x16x32_bf16 v[160:163], v[48:51], a[176:179], v[160:163]
    ds_read_b64_tr_b16 v[34:35], v4 offset:49408
    v_mfma_f32_16x16x32_bf16 v[164:167], v[48:51], a[180:183], v[164:167]
    ds_read_b64_tr_b16 v[36:37], v5 offset:49152
    s_add_u32 m0, s58, 16384
    s_add_u32 s54, s63, 65536
    buffer_load_dwordx4 v241, s[28:31], s54 offen sc1 lds
    v_mfma_f32_16x16x32_bf16 v[168:171], v[52:55], a[176:179], v[168:171]
    ds_read_b64_tr_b16 v[38:39], v5 offset:49408
    v_mfma_f32_16x16x32_bf16 v[172:175], v[52:55], a[180:183], v[172:175]
    ds_read_b64_tr_b16 v[40:41], v6 offset:49152
    v_mfma_f32_16x16x32_bf16 v[176:179], v[56:59], a[176:179], v[176:179]
    ds_read_b64_tr_b16 v[42:43], v6 offset:49408
    buffer_load_dwordx4 v241, s[28:31], s54 offen offset:1024 sc1 lds
    v_mfma_f32_16x16x32_bf16 v[180:183], v[56:59], a[180:183], v[180:183]
    ds_read_b64_tr_b16 v[44:45], v7 offset:49152
    v_mfma_f32_16x16x32_bf16 v[184:187], v[60:63], a[176:179], v[184:187]
    ds_read_b64_tr_b16 v[46:47], v7 offset:49408
    buffer_load_dwordx4 v241, s[28:31], s54 offen offset:2048 sc1 lds
    v_mfma_f32_16x16x32_bf16 v[188:191], v[60:63], a[180:183], v[188:191]
    ds_read_b128 v[144:147], v17 offset:24576
    s_waitcnt lgkmcnt(9)
    v_mfma_f32_16x16x32_bf16 v[192:195], v[128:131], v[152:155], v[192:195]
    ds_read_b64_tr_b16 v[48:49], v4 offset:53248
    v_mfma_f32_16x16x32_bf16 v[160:163], v[128:131], a[184:187], v[160:163]
    ds_read_b64_tr_b16 v[50:51], v4 offset:53504
    v_mfma_f32_16x16x32_bf16 v[164:167], v[128:131], a[188:191], v[164:167]
    ds_read_b64_tr_b16 v[52:53], v5 offset:53248
    buffer_load_dwordx4 v241, s[28:31], s54 offen offset:3072 sc1 lds
    v_mfma_f32_16x16x32_bf16 v[168:171], v[132:135], a[184:187], v[168:171]
    ds_read_b64_tr_b16 v[54:55], v5 offset:53504
    v_mfma_f32_16x16x32_bf16 v[172:175], v[132:135], a[188:191], v[172:175]
    ds_read_b64_tr_b16 v[56:57], v6 offset:53248
    v_mfma_f32_16x16x32_bf16 v[176:179], v[136:139], a[184:187], v[176:179]
    ds_read_b64_tr_b16 v[58:59], v6 offset:53504
    v_mfma_f32_16x16x32_bf16 v[180:183], v[136:139], a[188:191], v[180:183]
    ds_read_b64_tr_b16 v[60:61], v7 offset:53248
    v_mfma_f32_16x16x32_bf16 v[184:187], v[140:143], a[184:187], v[184:187]
    ds_read_b64_tr_b16 v[62:63], v7 offset:53504
    v_mfma_f32_16x16x32_bf16 v[188:191], v[140:143], a[188:191], v[188:191]
    ds_read_b128 v[148:151], v18 offset:24576
    s_waitcnt lgkmcnt(9)
    v_mfma_f32_16x16x32_bf16 v[192:195], v[32:35], v[144:147], v[192:195]
    s_waitcnt vmcnt(4)
    ds_read_b128 v[212:215], v15 offset:32768
    v_mfma_f32_16x16x32_bf16 v[160:163], v[32:35], a[192:195], v[160:163]
    ds_read_b128 v[216:219], v15 offset:34816
    ds_read_b128 v[220:223], v16 offset:32768
    v_mfma_f32_16x16x32_bf16 v[164:167], v[32:35], a[196:199], v[164:167]
    ds_read_b128 v[224:227], v16 offset:34816
    ds_read_b64_tr_b16 v[128:129], v4 offset:57344
    v_mfma_f32_16x16x32_bf16 v[168:171], v[36:39], a[192:195], v[168:171]
    ds_read_b64_tr_b16 v[130:131], v4 offset:57600
    ds_read_b64_tr_b16 v[132:133], v5 offset:57344
    v_mfma_f32_16x16x32_bf16 v[172:175], v[36:39], a[196:199], v[172:175]
    ds_read_b64_tr_b16 v[134:135], v5 offset:57600
    ds_read_b64_tr_b16 v[136:137], v6 offset:57344
    v_mfma_f32_16x16x32_bf16 v[176:179], v[40:43], a[192:195], v[176:179]
    ds_read_b64_tr_b16 v[138:139], v6 offset:57600
    v_mfma_f32_16x16x32_bf16 v[180:183], v[40:43], a[196:199], v[180:183]
    ds_read_b64_tr_b16 v[140:141], v7 offset:57344
    v_mfma_f32_16x16x32_bf16 v[184:187], v[44:47], a[192:195], v[184:187]
    ds_read_b64_tr_b16 v[142:143], v7 offset:57600
    v_mfma_f32_16x16x32_bf16 v[188:191], v[44:47], a[196:199], v[188:191]
    ds_read_b128 v[152:155], v17 offset:26624
    s_waitcnt lgkmcnt(13)
    v_mfma_f32_16x16x32_bf16 v[192:195], v[48:51], v[148:151], v[192:195]
    ds_read_b64_tr_b16 v[32:33], v4 offset:61440
    v_mfma_f32_16x16x32_bf16 v[160:163], v[48:51], a[200:203], v[160:163]
    ds_read_b64_tr_b16 v[34:35], v4 offset:61696
    v_mfma_f32_16x16x32_bf16 v[164:167], v[48:51], a[204:207], v[164:167]
    ds_read_b64_tr_b16 v[36:37], v5 offset:61440
    v_mfma_f32_16x16x32_bf16 v[168:171], v[52:55], a[200:203], v[168:171]
    ds_read_b64_tr_b16 v[38:39], v5 offset:61696
    v_mfma_f32_16x16x32_bf16 v[172:175], v[52:55], a[204:207], v[172:175]
    ds_read_b64_tr_b16 v[40:41], v6 offset:61440
    v_mfma_f32_16x16x32_bf16 v[176:179], v[56:59], a[200:203], v[176:179]
    ds_read_b64_tr_b16 v[42:43], v6 offset:61696
    v_mfma_f32_16x16x32_bf16 v[180:183], v[56:59], a[204:207], v[180:183]
    ds_read_b64_tr_b16 v[44:45], v7 offset:61440
    v_mfma_f32_16x16x32_bf16 v[184:187], v[60:63], a[200:203], v[184:187]
    ds_read_b64_tr_b16 v[46:47], v7 offset:61696
    v_mfma_f32_16x16x32_bf16 v[188:191], v[60:63], a[204:207], v[188:191]
    ds_read_b128 v[144:147], v18 offset:26624
    s_barrier
    s_waitcnt lgkmcnt(9)
    v_mfma_f32_16x16x32_bf16 v[192:195], v[128:131], v[152:155], v[192:195]
    ds_read_b64_tr_b16 v[48:49], v4 offset:0
    v_mfma_f32_16x16x32_bf16 v[160:163], v[128:131], a[208:211], v[160:163]
    ds_read_b64_tr_b16 v[50:51], v4 offset:256
    v_mfma_f32_16x16x32_bf16 v[164:167], v[128:131], a[212:215], v[164:167]
    ds_read_b128 v[104:107], v17 offset:28672
    v_mfma_f32_16x16x32_bf16 v[168:171], v[132:135], a[208:211], v[168:171]
    ds_read_b64_tr_b16 v[52:53], v4 offset:4096
    v_mfma_f32_16x16x32_bf16 v[172:175], v[132:135], a[212:215], v[172:175]
    ds_read_b64_tr_b16 v[54:55], v4 offset:4352
    v_mfma_f32_16x16x32_bf16 v[176:179], v[136:139], a[208:211], v[176:179]
    ds_read_b128 v[108:111], v18 offset:28672
    v_mfma_f32_16x16x32_bf16 v[180:183], v[136:139], a[212:215], v[180:183]
    ds_read_b64_tr_b16 v[56:57], v4 offset:8192
    v_mfma_f32_16x16x32_bf16 v[184:187], v[140:143], a[208:211], v[184:187]
    ds_read_b64_tr_b16 v[58:59], v4 offset:8448
    v_mfma_f32_16x16x32_bf16 v[188:191], v[140:143], a[212:215], v[188:191]
    ds_read_b128 v[112:115], v17 offset:30720
    s_waitcnt vmcnt(0)
    s_barrier
    s_waitcnt lgkmcnt(9)
    v_mfma_f32_16x16x32_bf16 v[192:195], v[32:35], v[144:147], v[192:195]
    ds_read_b64_tr_b16 v[128:129], v4 offset:12288
    v_mfma_f32_16x16x32_bf16 v[160:163], v[32:35], a[216:219], v[160:163]
    ds_read_b64_tr_b16 v[130:131], v4 offset:12544
    v_mfma_f32_16x16x32_bf16 v[164:167], v[32:35], a[220:223], v[164:167]
    ds_read_b128 v[116:119], v18 offset:30720
    v_mfma_f32_16x16x32_bf16 v[168:171], v[36:39], a[216:219], v[168:171]
    ds_read_b64_tr_b16 v[132:133], v4 offset:16384
    v_mfma_f32_16x16x32_bf16 v[172:175], v[36:39], a[220:223], v[172:175]
    ds_read_b64_tr_b16 v[134:135], v4 offset:16640
    v_mfma_f32_16x16x32_bf16 v[176:179], v[40:43], a[216:219], v[176:179]
    ds_read_b128 v[120:123], v17 offset:32768
    v_mfma_f32_16x16x32_bf16 v[180:183], v[40:43], a[220:223], v[180:183]
    ds_read_b64_tr_b16 v[136:137], v4 offset:20480
    v_mfma_f32_16x16x32_bf16 v[184:187], v[44:47], a[216:219], v[184:187]
    ds_read_b64_tr_b16 v[138:139], v4 offset:20736
    v_mfma_f32_16x16x32_bf16 v[188:191], v[44:47], a[220:223], v[188:191]
    ds_read_b128 v[124:127], v18 offset:32768
    s_waitcnt lgkmcnt(9)
    v_mfma_f32_16x16x32_bf16 v[192:195], v[56:59], v[112:115], v[192:195]
    ds_read_b64_tr_b16 v[32:33], v4 offset:24576
    v_mfma_f32_16x16x32_bf16 v[160:163], v[56:59], a[240:243], v[160:163]
    ds_read_b64_tr_b16 v[34:35], v4 offset:24832
    v_mfma_f32_16x16x32_bf16 v[164:167], v[56:59], a[244:247], v[164:167]
    ds_read_b128 v[92:95], v17 offset:34816
    v_mfma_f32_16x16x32_bf16 v[192:195], v[52:55], v[108:111], v[192:195]
    ds_read_b64_tr_b16 v[36:37], v4 offset:28672
    v_mfma_f32_16x16x32_bf16 v[160:163], v[52:55], a[232:235], v[160:163]
    ds_read_b64_tr_b16 v[38:39], v4 offset:28928
    v_mfma_f32_16x16x32_bf16 v[164:167], v[52:55], a[236:239], v[164:167]
    ds_read_b128 v[96:99], v18 offset:34816
    v_mfma_f32_16x16x32_bf16 v[192:195], v[48:51], v[104:107], v[192:195]
    v_mfma_f32_16x16x32_bf16 v[160:163], v[48:51], a[224:227], v[160:163]
    v_mfma_f32_16x16x32_bf16 v[164:167], v[48:51], a[228:231], v[164:167]
    s_waitcnt lgkmcnt(6)
    v_mfma_f32_16x16x32_bf16 v[192:195], v[136:139], v[124:127], v[192:195]
    ds_read_b64_tr_b16 v[48:49], v5 offset:0
    v_mfma_f32_16x16x32_bf16 v[160:163], v[136:139], v[204:207], v[160:163]
    ds_read_b64_tr_b16 v[50:51], v5 offset:256
    v_mfma_f32_16x16x32_bf16 v[164:167], v[136:139], v[208:211], v[164:167]
    ds_read_b64_tr_b16 v[52:53], v5 offset:4096
    v_mfma_f32_16x16x32_bf16 v[192:195], v[132:135], v[120:123], v[192:195]
    ds_read_b64_tr_b16 v[54:55], v5 offset:4352
    v_mfma_f32_16x16x32_bf16 v[160:163], v[132:135], v[196:199], v[160:163]
    ds_read_b64_tr_b16 v[56:57], v5 offset:8192
    v_mfma_f32_16x16x32_bf16 v[164:167], v[132:135], v[200:203], v[164:167]
    ds_read_b64_tr_b16 v[58:59], v5 offset:8448
    v_mfma_f32_16x16x32_bf16 v[192:195], v[128:131], v[116:119], v[192:195]
    ds_read_b64_tr_b16 v[60:61], v5 offset:12288
    v_mfma_f32_16x16x32_bf16 v[160:163], v[128:131], a[248:251], v[160:163]
    ds_read_b64_tr_b16 v[62:63], v5 offset:12544
    v_mfma_f32_16x16x32_bf16 v[164:167], v[128:131], a[252:255], v[164:167]
    s_waitcnt lgkmcnt(8)
    v_mfma_f32_16x16x32_bf16 v[192:195], v[36:39], v[96:99], v[192:195]
    ds_read_b64_tr_b16 v[128:129], v5 offset:16384
    ds_read_b64_tr_b16 v[130:131], v5 offset:16640
    v_mfma_f32_16x16x32_bf16 v[160:163], v[36:39], v[220:223], v[160:163]
    ds_read_b64_tr_b16 v[132:133], v5 offset:20480
    ds_read_b64_tr_b16 v[134:135], v5 offset:20736
    v_mfma_f32_16x16x32_bf16 v[164:167], v[36:39], v[224:227], v[164:167]
    ds_read_b64_tr_b16 v[136:137], v5 offset:24576
    v_mfma_f32_16x16x32_bf16 v[192:195], v[32:35], v[92:95], v[192:195]
    ds_read_b64_tr_b16 v[138:139], v5 offset:24832
    v_mfma_f32_16x16x32_bf16 v[160:163], v[32:35], v[212:215], v[160:163]
    ds_read_b64_tr_b16 v[140:141], v5 offset:28672
    v_mfma_f32_16x16x32_bf16 v[164:167], v[32:35], v[216:219], v[164:167]
    ds_read_b64_tr_b16 v[142:143], v5 offset:28928
    s_waitcnt lgkmcnt(8)
    v_mfma_f32_16x16x32_bf16 v[168:171], v[60:63], a[248:251], v[168:171]
    ds_read_b64_tr_b16 v[32:33], v6 offset:0
    v_mfma_f32_16x16x32_bf16 v[172:175], v[60:63], a[252:255], v[172:175]
    ds_read_b64_tr_b16 v[34:35], v6 offset:256
    buffer_store_dword v160, v8, s[32:35], s64 offen offset:0 nt
    v_mfma_f32_16x16x32_bf16 v[168:171], v[56:59], a[240:243], v[168:171]
    ds_read_b64_tr_b16 v[36:37], v6 offset:4096
    buffer_store_dword v164, v8, s[32:35], s64 offen offset:64 nt
    v_mfma_f32_16x16x32_bf16 v[172:175], v[56:59], a[244:247], v[172:175]
    ds_read_b64_tr_b16 v[38:39], v6 offset:4352
    buffer_store_dword v161, v8, s[32:35], s65 offen offset:0 nt
    v_mfma_f32_16x16x32_bf16 v[168:171], v[52:55], a[232:235], v[168:171]
    ds_read_b64_tr_b16 v[40:41], v6 offset:8192
    buffer_store_dword v165, v8, s[32:35], s65 offen offset:64 nt
    v_mfma_f32_16x16x32_bf16 v[172:175], v[52:55], a[236:239], v[172:175]
    ds_read_b64_tr_b16 v[42:43], v6 offset:8448
    buffer_store_dword v162, v8, s[32:35], s66 offen offset:0 nt
    v_mfma_f32_16x16x32_bf16 v[168:171], v[48:51], a[224:227], v[168:171]
    ds_read_b64_tr_b16 v[44:45], v6 offset:12288
    buffer_store_dword v166, v8, s[32:35], s66 offen offset:64 nt
    v_mfma_f32_16x16x32_bf16 v[172:175], v[48:51], a[228:231], v[172:175]
    ds_read_b64_tr_b16 v[46:47], v6 offset:12544
    buffer_store_dword v163, v8, s[32:35], s67 offen offset:0 nt
    buffer_store_dword v167, v8, s[32:35], s67 offen offset:64 nt
    s_waitcnt lgkmcnt(8)
    v_mfma_f32_16x16x32_bf16 v[168:171], v[140:143], v[220:223], v[168:171]
    ds_read_b64_tr_b16 v[48:49], v6 offset:16384
    v_mfma_f32_16x16x32_bf16 v[172:175], v[140:143], v[224:227], v[172:175]
    ds_read_b64_tr_b16 v[50:51], v6 offset:16640
    buffer_store_dword v192, v10, s[32:35], s64 offen nt
    v_mfma_f32_16x16x32_bf16 v[168:171], v[136:139], v[212:215], v[168:171]
    ds_read_b64_tr_b16 v[52:53], v6 offset:20480
    buffer_store_dword v193, v10, s[32:35], s65 offen nt
    v_mfma_f32_16x16x32_bf16 v[172:175], v[136:139], v[216:219], v[172:175]
    ds_read_b64_tr_b16 v[54:55], v6 offset:20736
    buffer_store_dword v194, v10, s[32:35], s66 offen nt
    v_mfma_f32_16x16x32_bf16 v[168:171], v[132:135], v[204:207], v[168:171]
    ds_read_b64_tr_b16 v[56:57], v6 offset:24576
    buffer_store_dword v195, v10, s[32:35], s67 offen nt
    v_mfma_f32_16x16x32_bf16 v[172:175], v[132:135], v[208:211], v[172:175]
    ds_read_b64_tr_b16 v[58:59], v6 offset:24832
    v_mfma_f32_16x16x32_bf16 v[168:171], v[128:131], v[196:199], v[168:171]
    ds_read_b64_tr_b16 v[60:61], v6 offset:28672
    v_mfma_f32_16x16x32_bf16 v[172:175], v[128:131], v[200:203], v[172:175]
    ds_read_b64_tr_b16 v[62:63], v6 offset:28928
    s_waitcnt lgkmcnt(8)
    v_mfma_f32_16x16x32_bf16 v[176:179], v[44:47], a[248:251], v[176:179]
    ds_read_b64_tr_b16 v[128:129], v7 offset:0
    v_mfma_f32_16x16x32_bf16 v[180:183], v[44:47], a[252:255], v[180:183]
    ds_read_b64_tr_b16 v[130:131], v7 offset:256
    buffer_store_dword v168, v9, s[32:35], s64 offen offset:0 nt
    v_mfma_f32_16x16x32_bf16 v[176:179], v[40:43], a[240:243], v[176:179]
    ds_read_b64_tr_b16 v[132:133], v7 offset:4096
    buffer_store_dword v172, v9, s[32:35], s64 offen offset:64 nt
    v_mfma_f32_16x16x32_bf16 v[180:183], v[40:43], a[244:247], v[180:183]
    ds_read_b64_tr_b16 v[134:135], v7 offset:4352
    buffer_store_dword v169, v9, s[32:35], s65 offen offset:0 nt
    v_mfma_f32_16x16x32_bf16 v[176:179], v[36:39], a[232:235], v[176:179]
    ds_read_b64_tr_b16 v[136:137], v7 offset:8192
    buffer_store_dword v173, v9, s[32:35], s65 offen offset:64 nt
    v_mfma_f32_16x16x32_bf16 v[180:183], v[36:39], a[236:239], v[180:183]
    ds_read_b64_tr_b16 v[138:139], v7 offset:8448
    buffer_store_dword v170, v9, s[32:35], s66 offen offset:0 nt
    v_mfma_f32_16x16x32_bf16 v[176:179], v[32:35], a[224:227], v[176:179]
    ds_read_b64_tr_b16 v[140:141], v7 offset:12288
    buffer_store_dword v174, v9, s[32:35], s66 offen offset:64 nt
    v_mfma_f32_16x16x32_bf16 v[180:183], v[32:35], a[228:231], v[180:183]
    ds_read_b64_tr_b16 v[142:143], v7 offset:12544
    buffer_store_dword v171, v9, s[32:35], s67 offen offset:0 nt
    buffer_store_dword v175, v9, s[32:35], s67 offen offset:64 nt
    s_waitcnt lgkmcnt(8)
    v_mfma_f32_16x16x32_bf16 v[176:179], v[60:63], v[220:223], v[176:179]
    ds_read_b64_tr_b16 v[32:33], v7 offset:16384
    v_mfma_f32_16x16x32_bf16 v[180:183], v[60:63], v[224:227], v[180:183]
    ds_read_b64_tr_b16 v[34:35], v7 offset:16640
    v_mfma_f32_16x16x32_bf16 v[176:179], v[56:59], v[212:215], v[176:179]
    ds_read_b64_tr_b16 v[36:37], v7 offset:20480
    v_mfma_f32_16x16x32_bf16 v[180:183], v[56:59], v[216:219], v[180:183]
    ds_read_b64_tr_b16 v[38:39], v7 offset:20736
    v_mfma_f32_16x16x32_bf16 v[176:179], v[52:55], v[204:207], v[176:179]
    ds_read_b64_tr_b16 v[40:41], v7 offset:24576
    v_mfma_f32_16x16x32_bf16 v[180:183], v[52:55], v[208:211], v[180:183]
    ds_read_b64_tr_b16 v[42:43], v7 offset:24832
    v_mfma_f32_16x16x32_bf16 v[176:179], v[48:51], v[196:199], v[176:179]
    ds_read_b64_tr_b16 v[44:45], v7 offset:28672
    v_mfma_f32_16x16x32_bf16 v[180:183], v[48:51], v[200:203], v[180:183]
    ds_read_b64_tr_b16 v[46:47], v7 offset:28928
    s_waitcnt lgkmcnt(8)
    v_mfma_f32_16x16x32_bf16 v[184:187], v[140:143], a[248:251], v[184:187]
    v_mfma_f32_16x16x32_bf16 v[188:191], v[140:143], a[252:255], v[188:191]
    s_nop 1
    buffer_store_dword v176, v8, s[32:35], s68 offen offset:0 nt
    s_nop 0
    buffer_store_dword v180, v8, s[32:35], s68 offen offset:64 nt
    v_mfma_f32_16x16x32_bf16 v[184:187], v[136:139], a[240:243], v[184:187]
    buffer_store_dword v177, v8, s[32:35], s69 offen offset:0 nt
    buffer_store_dword v181, v8, s[32:35], s69 offen offset:64 nt
    v_mfma_f32_16x16x32_bf16 v[188:191], v[136:139], a[244:247], v[188:191]
    buffer_store_dword v178, v8, s[32:35], s70 offen offset:0 nt
    buffer_store_dword v182, v8, s[32:35], s70 offen offset:64 nt
    v_mfma_f32_16x16x32_bf16 v[184:187], v[132:135], a[232:235], v[184:187]
    buffer_store_dword v179, v8, s[32:35], s71 offen offset:0 nt
    buffer_store_dword v183, v8, s[32:35], s71 offen offset:64 nt
    v_mfma_f32_16x16x32_bf16 v[188:191], v[132:135], a[236:239], v[188:191]
    v_mfma_f32_16x16x32_bf16 v[184:187], v[128:131], a[224:227], v[184:187]
    v_mfma_f32_16x16x32_bf16 v[188:191], v[128:131], a[228:231], v[188:191]
    s_waitcnt lgkmcnt(0)
    v_mfma_f32_16x16x32_bf16 v[184:187], v[44:47], v[220:223], v[184:187]
    v_mfma_f32_16x16x32_bf16 v[188:191], v[44:47], v[224:227], v[188:191]
    v_mfma_f32_16x16x32_bf16 v[184:187], v[40:43], v[212:215], v[184:187]
    v_mfma_f32_16x16x32_bf16 v[188:191], v[40:43], v[216:219], v[188:191]
    v_mfma_f32_16x16x32_bf16 v[184:187], v[36:39], v[204:207], v[184:187]
    v_mfma_f32_16x16x32_bf16 v[188:191], v[36:39], v[208:211], v[188:191]
    v_mfma_f32_16x16x32_bf16 v[184:187], v[32:35], v[196:199], v[184:187]
    v_mfma_f32_16x16x32_bf16 v[188:191], v[32:35], v[200:203], v[188:191]
    s_nop 6
    buffer_store_dword v184, v9, s[32:35], s68 offen offset:0 nt
    buffer_store_dword v188, v9, s[32:35], s68 offen offset:64 nt
    buffer_store_dword v185, v9, s[32:35], s69 offen offset:0 nt
    buffer_store_dword v189, v9, s[32:35], s69 offen offset:64 nt
    buffer_store_dword v186, v9, s[32:35], s70 offen offset:0 nt
    buffer_store_dword v190, v9, s[32:35], s70 offen offset:64 nt
    buffer_store_dword v187, v9, s[32:35], s71 offen offset:0 nt
    buffer_store_dword v191, v9, s[32:35], s71 offen offset:64 nt
L_end:
    s_endpgm
L_clr_loop:
    s_sleep 2
    buffer_load_dword v194, v155, s[36:39], 0 offen sc1
    s_add_u32 s76, s76, 1
    s_cmp_gt_u32 s76, 200000
    s_waitcnt vmcnt(0)
    v_cmp_gt_u32 vcc, 4, v194
    s_cbranch_scc1 L_clr_ok
    s_cbranch_vccnz L_clr_loop
    s_branch L_clr_ok
L_lw1:
    ds_write_b128 v242, v[48:51] offset:16384
    ds_write_b128 v242, v[80:83] offset:24576
    ds_write_b128 v242, v[56:59] offset:17408
    ds_write_b128 v242, v[88:91] offset:25600
    s_branch L_lw_join
L_g_retry:
    buffer_load_dwordx2 v[228:229], v22, s[40:43], 0 offen sc1
    buffer_load_dwordx4 v[208:211], v26, s[40:43], 0 offen sc1
    buffer_load_dwordx2 v[230:231], v23, s[40:43], 0 offen sc1
    buffer_load_dwordx4 v[212:215], v27, s[40:43], 0 offen sc1
    buffer_load_dwordx2 v[232:233], v24, s[40:43], 0 offen sc1
    buffer_load_dwordx4 v[216:219], v28, s[40:43], 0 offen sc1
    buffer_load_dwordx2 v[234:235], v25, s[40:43], 0 offen sc1
    buffer_load_dwordx4 v[220:223], v29, s[40:43], 0 offen sc1
    s_add_u32 s76, s76, 1
    s_cmp_gt_u32 s76, 200000
    s_waitcnt vmcnt(0)
    v_max3_u32 v236, v228, v229, v230
    v_max3_u32 v237, v231, v232, v233
    v_max3_u32 v236, v236, v234, v235
    v_max3_u32 v237, v237, v208, v209
    v_max3_u32 v236, v236, v210, v211
    v_max3_u32 v237, v237, v212, v213
    v_max3_u32 v236, v236, v214, v215
    v_max3_u32 v237, v237, v216, v217
    v_max3_u32 v236, v236, v218, v219
    v_max3_u32 v237, v237, v220, v221
    v_max3_u32 v236, v236, v222, v223
    v_max_u32 v236, v236, v237
    v_cmp_eq_u32 vcc, -1, v236
    s_cbranch_scc1 L_g_ok
    s_cbranch_vccnz L_g_retry
    s_branch L_g_ok
L_f_loop:
    buffer_load_dword v232, v127, s[28:31], 0 offen sc1
    s_add_u32 s76, s76, 1
    s_cmp_gt_u32 s76, 200000
    s_waitcnt vmcnt(0)
    v_cmp_gt_u32 vcc, 1, v232
    s_cbranch_scc1 L_f_ok
    s_cbranch_vccz L_f_ok
    s_sleep 0
    s_cbranch_vccnz L_f_loop
    s_branch L_f_ok
L_code_end:
.section .rodata,"a"
.p2align 6
.amdhsa_kernel concat_heads__ssm_conv_s5__ssm_conv_s5__prompt_kernel
  .amdhsa_next_free_vgpr 512
  .amdhsa_next_free_sgpr 102
  .amdhsa_accum_offset 256
  .amdhsa_group_segment_fixed_size 0
  .amdhsa_kernarg_size 168
  .amdhsa_user_sgpr_count 2
  .amdhsa_user_sgpr_kernarg_segment_ptr 1
  .amdhsa_system_sgpr_workgroup_id_x 1
.end_amdhsa_kernel
```
